```python
import torch

def _softmax(x, axis=-1):
    return torch.softmax(x, dim=axis)
def _gelu(x):
    return torch.nn.functional.gelu(x, approximate="tanh")
def _silu(x):
    return torch.nn.functional.silu(x)
def _sigmoid(x):
    return torch.sigmoid(x)
def _layernorm(x, axis=-1, eps=1e-5):
    m = x.mean(dim=axis, keepdim=True)
    v = x.var(dim=axis, keepdim=True, unbiased=False)
    return (x - m) / torch.sqrt(v + eps)
def _scatter_add(tgt, idx, src, axis=0):
    return tgt.clone().index_add_(axis, idx, src)
def _segment_sum(src, seg, n):
    out = torch.zeros((n,) + src.shape[1:], dtype=src.dtype)
    return out.index_add_(0, seg, src)
def _pad(x, pw):
    flat = tuple(v for pair in reversed(pw) for v in pair)
    return torch.nn.functional.pad(x, flat)

kernel_name = 'concat_heads__sliding_block__sliding_block__prompt'

def setup_inputs():

    _w = (lambda a: (lambda t: t.to(torch.bfloat16) if t.is_floating_point() else t)(torch.as_tensor(a)))
    def _A_setup():
        B, S, D = 1, 2048, 640
        return {
            "x": _w((lambda *s: torch.randn(*s, dtype=torch.bfloat16) * 0.2)(B, S, D)),
            "wqkv": _w((lambda *s: torch.randn(*s, dtype=torch.bfloat16) * 0.2)(D, 3 * D)),
            "wo": _w((lambda *s: torch.randn(*s, dtype=torch.bfloat16) * 0.05)(D, D)),
        }
    _A_in = _A_setup()

    def _B_setup():
        B, S, D = 1, 2048, 640
        return {
            "x": _w((lambda *s: torch.randn(*s, dtype=torch.bfloat16) * 0.2)(B, S, D)),
            "wqkv": _w((lambda *s: torch.randn(*s, dtype=torch.bfloat16) * 0.2)(D, 3 * D)),
            "wo": _w((lambda *s: torch.randn(*s, dtype=torch.bfloat16) * 0.05)(D, D)),
        }
    _B_in = _B_setup()

    return {
        "A_x": _A_in["x"],
        "A_wqkv": _A_in["wqkv"],
        "A_wo": _A_in["wo"],
        "B_x": _B_in["x"],
        "B_wqkv": _B_in["wqkv"],
        "B_wo": _B_in["wo"],
    }

def reference(A_x, A_wqkv, A_wo, B_x, B_wqkv, B_wo):
    def _A_ref(x, wqkv, wo):
        B, S, D = x.shape
        H = 32; Dh = D // H; W = 256
        qkv = (lambda x, *d: x.permute(*d))((x @ wqkv).reshape(B, S, 3, H, Dh), 2, 0, 3, 1, 4)
        q, k, v = qkv[0], qkv[1], qkv[2]
        scores = torch.einsum("bhqd,bhkd->bhqk", q, k) * (Dh ** -0.5)
        idx = torch.arange(S)
        mask = (idx[:, None] - idx[None, :] >= 0) & (idx[:, None] - idx[None, :] < W)
        scores = torch.where(mask[None, None], scores, -1e9)
        p = _softmax(scores, axis=-1)
        o = torch.einsum("bhqk,bhkd->bhqd", p, v)
        return (lambda x, *d: x.permute(*d))(o, 0, 2, 1, 3).reshape(B, S, D) @ wo

    def _B_ref(x, wqkv, wo):
        B, S, D = x.shape
        H = 32; Dh = D // H; W = 256
        qkv = (lambda x, *d: x.permute(*d))((x @ wqkv).reshape(B, S, 3, H, Dh), 2, 0, 3, 1, 4)
        q, k, v = qkv[0], qkv[1], qkv[2]
        scores = torch.einsum("bhqd,bhkd->bhqk", q, k) * (Dh ** -0.5)
        idx = torch.arange(S)
        mask = (idx[:, None] - idx[None, :] >= 0) & (idx[:, None] - idx[None, :] < W)
        scores = torch.where(mask[None, None], scores, -1e9)
        p = _softmax(scores, axis=-1)
        o = torch.einsum("bhqk,bhkd->bhqd", p, v)
        return (lambda x, *d: x.permute(*d))(o, 0, 2, 1, 3).reshape(B, S, D) @ wo

    a = _A_ref(A_x, A_wqkv, A_wo)
    b = _B_ref(B_x, B_wqkv, B_wo)
    return torch.concatenate([a, b], axis=-1)
```

```asm
; @launch grid=(256,1,1) block=(256,1,1) lds=163840
.amdgcn_target "amdgcn-amd-amdhsa--gfx950"
.text
.globl concat_heads__sliding_block__sliding_block__prompt_kernel
.p2align 8
.type concat_heads__sliding_block__sliding_block__prompt_kernel,@function
concat_heads__sliding_block__sliding_block__prompt_kernel:
    s_cmpk_ge_u32 s2, 256
    s_cbranch_scc1 L_exit
    s_and_b32 s3, s2, 4
    s_mul_i32 s3, s3, 6
    s_load_dwordx2 s[8:9], s[0:1], s3
    s_load_dwordx2 s[12:13], s[0:1], s3 offset:8
    s_getpc_b64 s[4:5]
L_pc:
    v_lshlrev_b32 v63, 3, v0
    global_load_dword v219, v63, s[4:5] offset:320
    s_lshl_b32 s59, s2, 8
    v_add_u32 v63, s59, v63
    v_min_u32 v63, L_exit-L_pc-576, v63
    global_load_dword v219, v63, s[4:5] offset:576
    v_readfirstlane_b32 s35, v0
    v_and_b32 v1, 63, v0
    s_and_b32 s56, s2, 3
    s_lshr_b32 s57, s2, 6
    s_lshl2_add_u32 s33, s56, s57
    s_bfe_u32 s34, s2, 0x30003
    s_lshr_b32 s35, s35, 6
    s_lshl_b32 s56, s56, 2
    s_lshr_b32 s65, 0x8530, s56
    s_and_b32 s65, s65, 15
    s_add_u32 s58, s34, s33
    s_lshl_b32 s56, s58, 3
    s_lshr_b32 s55, 0x20100, s56
    s_and_b32 s55, s55, 15
    s_add_u32 s55, s55, s65
    s_sub_u32 s56, s55, 10
    s_min_u32 s55, s55, s56
    v_lshrrev_b32 v2, 3, v1
    v_lshrrev_b32 v3, 4, v1
    v_and_b32 v4, 7, v1
    v_xor_b32 v4, v4, v3
    v_mul_u32_u24 v2, 1280, v2
    v_lshl_add_u32 v10, v4, 4, v2
    s_lshl2_add_u32 s97, s33, s35
    s_mulk_i32 s97, 320
    s_add_u32 s60, s97, s55
    s_lshl_b32 s60, s60, 7
    s_lshl_b32 m0, s35, 12
    s_lshl_b32 s10, 40, 16
    s_mov_b32 s11, 0x00020000
    v_xor_b32 v5, 64, v10
    v_add_u32 v11, 9216, v5
    s_mov_b64 s[14:15], s[10:11]
    s_lshr_b32 s56, s35, 1
    s_mulk_i32 s56, 94
    s_add_u32 s56, s56, s35
    s_add_u32 s56, s56, 1
    s_lshl3_add_u32 s64, s56, s34
    s_mulk_i32 s55, 1536
    s_add_u32 s61, s55, s64
    s_mulk_i32 s61, 160
    s_add_u32 s63, s35, 16
    s_mulk_i32 s63, 5120
    v_lshlrev_b32 v9, 4, v1
    s_movk_i32 s56, 3680
    s_movk_i32 s59, 15360
    s_movk_i32 s57, 13120
    v_mul_u32_u24 v2, 205, v1
    s_waitcnt lgkmcnt(0)
    buffer_load_dwordx4 v10, s[8:11], s60 offen offset:0 lds
    buffer_load_dwordx4 v11, s[8:11], s60 offen offset:1024 lds
    s_addk_i32 s60, 18432
    buffer_load_dwordx4 v10, s[8:11], s60 offen offset:2048 lds
    buffer_load_dwordx4 v11, s[8:11], s60 offen offset:3072 lds
    s_mov_b32 m0, s63
    v_lshrrev_b32 v19, 11, v2
    v_mad_u32_u24 v14, v19, s56, v9
    v_bfe_u32 v3, v19, 2, 1
    v_bfe_u32 v4, v19, 3, 1
    v_sub_u32 v3, v3, v4
    v_mad_i32_i24 v14, v3, s59, v14
    buffer_load_dwordx4 v14, s[12:15], s61 offen offset:0 lds
    v_add_u32 v2, s57, v2
    v_lshrrev_b32 v20, 11, v2
    v_mad_u32_u24 v15, v20, s56, v9
    v_bfe_u32 v3, v20, 2, 1
    v_bfe_u32 v4, v20, 3, 1
    v_sub_u32 v3, v3, v4
    v_mad_i32_i24 v15, v3, s59, v15
    buffer_load_dwordx4 v15, s[12:15], s61 offen offset:1024 lds
    v_add_u32 v2, s57, v2
    v_lshrrev_b32 v21, 11, v2
    v_mad_u32_u24 v16, v21, s56, v9
    v_bfe_u32 v3, v21, 2, 1
    v_bfe_u32 v4, v21, 3, 1
    v_sub_u32 v3, v3, v4
    v_mad_i32_i24 v16, v3, s59, v16
    buffer_load_dwordx4 v16, s[12:15], s61 offen offset:2048 lds
    v_add_u32 v2, s57, v2
    v_lshrrev_b32 v22, 11, v2
    v_mad_u32_u24 v17, v22, s56, v9
    v_bfe_u32 v3, v22, 2, 1
    v_bfe_u32 v4, v22, 3, 1
    v_sub_u32 v3, v3, v4
    v_mad_i32_i24 v17, v3, s59, v17
    buffer_load_dwordx4 v17, s[12:15], s61 offen offset:3072 lds
    v_add_u32 v2, s57, v2
    v_lshrrev_b32 v23, 11, v2
    v_mad_u32_u24 v18, v23, s56, v9
    v_bfe_u32 v3, v23, 2, 1
    v_bfe_u32 v4, v23, 3, 1
    v_sub_u32 v3, v3, v4
    v_mad_i32_i24 v18, v3, s59, v18
    v_add_u32 v18, 4096, v18
    s_addk_i32 m0, 4096
    s_nop 0
    buffer_load_dwordx4 v18, s[12:15], s61 offen offset:0 lds
    s_load_dwordx2 s[16:17], s[0:1], s3 offset:16
    s_load_dwordx2 s[20:21], s[0:1], 48
    s_load_dwordx2 s[28:29], s[0:1], 56
    s_load_dwordx2 s[24:25], s[0:1], 64
    s_mov_b32 s14, 2457600
    s_mulk_i32 s64, 160
    s_mul_i32 s63, s35, 5120
    s_bitcmp1_b32 s58, 0
    s_mov_b32 s100, 0x76453210
    s_cmov_b32 s100, 0x75643021
    s_mov_b32 s101, 0x89
    s_cmov_b32 s101, 0x98
    s_mov_b32 s98, 0x67541302
    s_cmov_b32 s98, 0x86534210
    s_mov_b32 s99, 0x98
    s_cmov_b32 s99, 0x97
    s_bitcmp0_b32 s58, 1
    s_cmov_b64 s[98:99], s[100:101]
    s_lshl_b32 s62, s35, 12
    s_and_b32 s42, s58, 3
    v_lshrrev_b32 v2, 4, v1
    v_and_b32 v3, 15, v1
    v_lshrrev_b32 v4, 5, v1
    v_bfe_u32 v5, v1, 4, 1
    v_bfe_u32 v6, v1, 2, 2
    v_and_b32 v7, 3, v1
    v_mul_u32_u24 v7, 40, v7
    v_lshl_add_u32 v8, v5, 2, v6
    v_lshl_add_u32 v8, v4, 4, v8
    v_mul_u32_u24 v8, 160, v8
    v_add_u32 v8, v8, v7
    v_add_u32 v24, 61440, v8
    v_add_u32 v25, 122880, v8
    v_lshrrev_b32 v8, 1, v3
    v_xor_b32 v8, v8, v2
    v_lshl_add_u32 v27, v3, 7, s62
    v_lshl_add_u32 v27, v8, 4, v27
    v_xor_b32 v28, 64, v27
    s_mov_b32 s18, 819200
    s_mov_b32 s19, 0x00020000
    s_mov_b32 s22, 5242880
    s_mov_b32 s23, 0x00020000
    s_mov_b32 s30, 256
    s_mov_b32 s31, 0x00020000
    s_mov_b32 s26, 33554432
    s_mov_b32 s27, 0x00020000
    s_waitcnt lgkmcnt(0)
    s_or_b32 s56, s2, s35
    s_cbranch_scc0 L_mknonce
L_nononce:
    v_and_b32 v8, 27, v1
    v_cmp_eq_u32 vcc, 24, v8
    v_mov_b32 v8, 0x3F003700
    s_nop 0
    v_cndmask_b32 v176, 0, v8, vcc
    v_mov_b32 v178, 0x3F8042FE
    v_mov_b32 v177, 0
    v_mov_b32 v179, 0
    v_mov_b32 v181, 0
    v_mov_b32 v183, 0
    s_cmp_ge_u32 s33, 1
    s_cselect_b32 s56, 0x3F8042FE, 0
    v_mov_b32 v180, s56
    s_cmp_ge_u32 s33, 2
    s_cselect_b32 s56, 0x3F8042FE, 0
    v_mov_b32 v182, s56
    s_bfe_u32 s32, s2, 0x10002
    s_lshl4_add_u32 s59, s32, s33
    v_mfma_f32_32x32x8_bf16 a[160:175], v[178:179], v[176:177], 0
    s_lshl3_add_u32 s54, s59, s34
    s_mul_i32 s36, s59, 163840
    s_add_u32 s36, s36, 10485760
    s_and_b32 s56, s35, 2
    s_mul_i32 s56, s56, 2
    s_lshr_b64 s[100:101], s[98:99], s56
    s_and_b32 s37, s35, 1
    s_mul_i32 s67, s37, 122880
    s_mul_i32 s47, s34, 160
    s_add_u32 s67, s67, s47
    v_mfma_f32_32x32x8_bf16 a[176:191], v[178:179], v[176:177], 0
    s_bfe_u32 s56, s100, 0x40000
    s_add_u32 s56, s56, s65
    s_sub_u32 s57, s56, 10
    s_min_u32 s56, s56, s57
    s_mul_i32 s56, s56, 245760
    s_add_u32 s48, s56, s67
    v_mfma_f32_32x32x8_bf16 a[192:207], v[180:181], v[176:177], 0
    s_bfe_u32 s56, s100, 0x40008
    s_add_u32 s56, s56, s65
    s_sub_u32 s57, s56, 10
    s_min_u32 s56, s56, s57
    s_mul_i32 s56, s56, 245760
    s_add_u32 s49, s56, s67
    v_mfma_f32_32x32x8_bf16 a[208:223], v[180:181], v[176:177], 0
    s_bfe_u32 s56, s100, 0x40010
    s_add_u32 s56, s56, s65
    s_sub_u32 s57, s56, 10
    s_min_u32 s56, s56, s57
    s_mul_i32 s56, s56, 245760
    s_add_u32 s50, s56, s67
    v_mfma_f32_32x32x8_bf16 a[224:239], v[182:183], v[176:177], 0
    s_bfe_u32 s56, s100, 0x40018
    s_add_u32 s56, s56, s65
    s_sub_u32 s57, s56, 10
    s_min_u32 s56, s56, s57
    s_mul_i32 s56, s56, 245760
    s_add_u32 s51, s56, s67
    v_mfma_f32_32x32x8_bf16 a[240:255], v[182:183], v[176:177], 0
    s_bfe_u32 s56, s101, 0x40000
    s_add_u32 s56, s56, s65
    s_sub_u32 s57, s56, 10
    s_min_u32 s56, s56, s57
    s_mul_i32 s56, s56, 245760
    s_add_u32 s52, s56, s67
    s_movk_i32 s58, 1120
    v_mad_u32_u24 v19, v19, s58, v9
    v_mad_u32_u24 v20, v20, s58, v9
    v_mad_u32_u24 v21, v21, s58, v9
    v_mad_u32_u24 v22, v22, s58, v9
    v_mad_u32_u24 v23, v23, s58, v9
    v_add_u32 v23, 4096, v23
    s_movk_i32 s68, 640
    v_add_u32 v8, 1, v4
    v_min_u32 v8, s33, v8
    v_mul_u32_u24 v8, 20480, v8
    s_add_u32 m0, s62, 16384
    s_bfe_u32 s55, s98, 0x40004
    s_add_u32 s55, s55, s65
    s_sub_u32 s60, s55, 10
    s_min_u32 s55, s55, s60
    s_add_u32 s60, s55, s97
    s_lshl_b32 s60, s60, 7
    buffer_load_dwordx4 v10, s[8:11], s60 offen offset:0 lds
    buffer_load_dwordx4 v11, s[8:11], s60 offen offset:1024 lds
    s_addk_i32 s60, 18432
    buffer_load_dwordx4 v10, s[8:11], s60 offen offset:2048 lds
    buffer_load_dwordx4 v11, s[8:11], s60 offen offset:3072 lds
    s_add_u32 m0, s63, 102400
    s_mul_i32 s61, s55, 245760
    s_add_u32 s61, s61, s64
    buffer_load_dwordx4 v14, s[12:15], s61 offen offset:0 lds
    buffer_load_dwordx4 v15, s[12:15], s61 offen offset:1024 lds
    buffer_load_dwordx4 v16, s[12:15], s61 offen offset:2048 lds
    buffer_load_dwordx4 v17, s[12:15], s61 offen offset:3072 lds
    s_add_u32 m0, s63, 106496
    s_nop 0
    buffer_load_dwordx4 v18, s[12:15], s61 offen lds
    s_waitcnt vmcnt(9)
    s_barrier
    ds_read_b128 a[0:3], v27 offset:0
    ds_read_b128 a[4:7], v27 offset:2048
    ds_read_b64_tr_b16 v[144:145], v24 offset:20480
    ds_read_b64_tr_b16 v[146:147], v24 offset:21760
    ds_read_b64_tr_b16 v[148:149], v24 offset:20488
    ds_read_b64_tr_b16 v[150:151], v24 offset:21768
    ds_read_b64_tr_b16 v[152:153], v24 offset:20496
    ds_read_b64_tr_b16 v[154:155], v24 offset:21776
    ds_read_b64_tr_b16 v[156:157], v24 offset:20504
    ds_read_b64_tr_b16 v[158:159], v24 offset:21784
    ds_read_b64_tr_b16 v[160:161], v24 offset:20512
    ds_read_b64_tr_b16 v[162:163], v24 offset:21792
    ds_read_b64_tr_b16 v[164:165], v24 offset:25600
    ds_read_b64_tr_b16 v[166:167], v24 offset:26880
    s_waitcnt lgkmcnt(8)
    v_mfma_f32_16x16x32_bf16 v[64:67], v[144:147], a[0:3], 0
    ds_read_b64_tr_b16 v[168:169], v24 offset:25608
    s_add_u32 m0, s62, 32768
    s_mul_i32 s56, s54, 2560
    v_mfma_f32_16x16x32_bf16 v[68:71], v[144:147], a[4:7], 0
    ds_read_b64_tr_b16 v[170:171], v24 offset:26888
    s_bfe_u32 s55, s98, 0x40008
    v_mfma_f32_16x16x32_bf16 v[72:75], v[148:151], a[0:3], 0
    ds_read_b64_tr_b16 v[172:173], v24 offset:25616
    s_add_u32 s55, s55, s65
    s_add_u32 s56, s56, 25165824
    v_mfma_f32_16x16x32_bf16 v[76:79], v[148:151], a[4:7], 0
    ds_read_b64_tr_b16 v[174:175], v24 offset:26896
    s_sub_u32 s60, s55, 10
    s_waitcnt lgkmcnt(8)
    v_mfma_f32_16x16x32_bf16 v[80:83], v[152:155], a[0:3], 0
    ds_read_b64_tr_b16 v[144:145], v24 offset:25624
    s_min_u32 s55, s55, s60
    v_sub_u32 v7, s56, v8
    v_mfma_f32_16x16x32_bf16 v[84:87], v[152:155], a[4:7], 0
    ds_read_b64_tr_b16 v[146:147], v24 offset:26904
    s_add_u32 s60, s55, s97
    v_mfma_f32_16x16x32_bf16 v[88:91], v[156:159], a[0:3], 0
    ds_read_b64_tr_b16 v[148:149], v24 offset:25632
    s_lshl_b32 s60, s60, 7
    v_mad_u32_u24 v45, v5, s68, v7
    v_mfma_f32_16x16x32_bf16 v[92:95], v[156:159], a[4:7], 0
    ds_read_b64_tr_b16 v[150:151], v24 offset:26912
    buffer_load_dwordx4 v10, s[8:11], s60 offen offset:0 lds
    s_waitcnt lgkmcnt(8)
    v_mfma_f32_16x16x32_bf16 v[96:99], v[160:163], a[0:3], 0
    ds_read_b64_tr_b16 v[152:153], v24 offset:30720
    buffer_load_dwordx4 v11, s[8:11], s60 offen offset:1024 lds
    ds_read_b128 a[8:11], v28 offset:0
    s_mul_i32 s57, s35, 640
    v_mfma_f32_16x16x32_bf16 v[100:103], v[160:163], a[4:7], 0
    ds_read_b64_tr_b16 v[154:155], v24 offset:32000
    s_addk_i32 s60, 18432
    v_mfma_f32_16x16x32_bf16 v[104:107], a[0:3], v[164:167], 0
    ds_read_b64_tr_b16 v[156:157], v24 offset:30728
    buffer_load_dwordx4 v10, s[8:11], s60 offen offset:2048 lds
    ds_read_b128 a[12:15], v28 offset:2048
    s_add_u32 s56, s56, s57
    v_mfma_f32_16x16x32_bf16 v[108:111], a[4:7], v[164:167], 0
    ds_read_b64_tr_b16 v[158:159], v24 offset:32008
    buffer_load_dwordx4 v11, s[8:11], s60 offen offset:3072 lds
    s_waitcnt lgkmcnt(10)
    v_mfma_f32_16x16x32_bf16 v[112:115], a[0:3], v[168:171], 0
    ds_read_b64_tr_b16 v[160:161], v24 offset:30736
    s_add_u32 m0, s63, 122880
    v_add_u32 v7, s57, v7
    v_mfma_f32_16x16x32_bf16 v[116:119], a[4:7], v[168:171], 0
    ds_read_b64_tr_b16 v[162:163], v24 offset:32016
    s_mul_i32 s61, s55, 245760
    v_mfma_f32_16x16x32_bf16 v[120:123], a[0:3], v[172:175], 0
    ds_read_b64_tr_b16 v[164:165], v24 offset:30744
    s_add_u32 s61, s61, s64
    v_and_b32 v8, 56, v1
    v_mfma_f32_16x16x32_bf16 v[124:127], a[4:7], v[172:175], 0
    ds_read_b64_tr_b16 v[166:167], v24 offset:32024
    buffer_load_dwordx4 v14, s[12:15], s61 offen offset:0 lds
    s_waitcnt lgkmcnt(10)
    v_mfma_f32_16x16x32_bf16 v[128:131], a[0:3], v[144:147], 0
    ds_read_b64_tr_b16 v[168:169], v24 offset:30752
    buffer_load_dwordx4 v15, s[12:15], s61 offen offset:1024 lds
    v_lshl_add_u32 v8, v8, 23, v9
    v_mfma_f32_16x16x32_bf16 v[132:135], a[4:7], v[144:147], 0
    ds_read_b64_tr_b16 v[170:171], v24 offset:32032
    buffer_load_dwordx4 v16, s[12:15], s61 offen offset:2048 lds
    v_mfma_f32_16x16x32_bf16 v[136:139], a[0:3], v[148:151], 0
    ds_read_b64_tr_b16 v[172:173], v24 offset:35840
    v_add_u32 v60, s56, v8
    v_mfma_f32_16x16x32_bf16 v[140:143], a[4:7], v[148:151], 0
    ds_read_b64_tr_b16 v[174:175], v24 offset:37120
    s_waitcnt lgkmcnt(8)
    v_mfma_f32_16x16x32_bf16 v[64:67], v[152:155], a[8:11], v[64:67]
    ds_read_b64_tr_b16 v[144:145], v24 offset:35848
    buffer_load_dwordx4 v17, s[12:15], s61 offen offset:3072 lds
    s_add_u32 s56, s56, 128
    v_mfma_f32_16x16x32_bf16 v[68:71], v[152:155], a[12:15], v[68:71]
    ds_read_b64_tr_b16 v[146:147], v24 offset:37128
    s_add_u32 m0, s63, 126976
    v_mfma_f32_16x16x32_bf16 v[72:75], v[156:159], a[8:11], v[72:75]
    ds_read_b64_tr_b16 v[148:149], v24 offset:35856
    s_and_b32 s43, s54, 127
    v_cmp_gt_u32 vcc, 8, v3
    v_lshl_add_u32 v8, v2, 7, s56
    s_mul_i32 s69, s54, 40960
    v_cndmask_b32 v63, v8, v7, vcc
    v_mfma_f32_16x16x32_bf16 v[76:79], v[156:159], a[12:15], v[76:79]
    ds_read_b64_tr_b16 v[150:151], v24 offset:37136
    s_waitcnt lgkmcnt(8)
    v_mfma_f32_16x16x32_bf16 v[80:83], v[160:163], a[8:11], v[80:83]
    ds_read_b64_tr_b16 v[152:153], v24 offset:35864
    buffer_load_dwordx4 v18, s[12:15], s61 offen lds
    s_add_u32 s46, s69, 20480
    v_mfma_f32_16x16x32_bf16 v[84:87], v[160:163], a[12:15], v[84:87]
    ds_read_b64_tr_b16 v[154:155], v24 offset:37144
    s_add_u32 m0, s62, 49152
    v_mfma_f32_16x16x32_bf16 v[88:91], v[164:167], a[8:11], v[88:91]
    ds_read_b64_tr_b16 v[156:157], v24 offset:35872
    s_bfe_u32 s55, s98, 0x4000c
    s_bitcmp1_b32 s35, 1
    s_cselect_b32 s90, 33554432, 0
    s_cselect_b32 s94, 0, 33554432
    v_mfma_f32_16x16x32_bf16 v[92:95], v[164:167], a[12:15], v[92:95]
    ds_read_b64_tr_b16 v[158:159], v24 offset:37152
    s_add_u32 s55, s55, s65
    s_waitcnt vmcnt(9)
    s_barrier
    s_waitcnt lgkmcnt(8)
    v_mfma_f32_16x16x32_bf16 v[96:99], v[168:171], a[8:11], v[96:99]
    ds_read_b64_tr_b16 v[160:161], v24 offset:40960
    s_sub_u32 s60, s55, 10
    ds_read_b128 a[16:19], v27 offset:16384
    s_mov_b64 s[88:89], s[24:25]
    v_mfma_f32_16x16x32_bf16 v[100:103], v[168:171], a[12:15], v[100:103]
    ds_read_b64_tr_b16 v[162:163], v24 offset:42240
    s_min_u32 s55, s55, s60
    v_mfma_f32_16x16x32_bf16 v[104:107], a[8:11], v[172:175], v[104:107]
    ds_read_b64_tr_b16 v[164:165], v24 offset:40968
    s_add_u32 s60, s55, s97
    ds_read_b128 a[20:23], v27 offset:18432
    s_mov_b32 s91, 0x00020000
    v_mfma_f32_16x16x32_bf16 v[108:111], a[12:15], v[172:175], v[108:111]
    ds_read_b64_tr_b16 v[166:167], v24 offset:42248
    s_lshl_b32 s60, s60, 7
    s_waitcnt lgkmcnt(10)
    v_mfma_f32_16x16x32_bf16 v[112:115], a[8:11], v[144:147], v[112:115]
    ds_read_b64_tr_b16 v[168:169], v24 offset:40976
    buffer_load_dwordx4 v10, s[8:11], s60 offen offset:0 lds
    s_mov_b64 s[92:93], s[24:25]
    v_mfma_f32_16x16x32_bf16 v[116:119], a[12:15], v[144:147], v[116:119]
    ds_read_b64_tr_b16 v[170:171], v24 offset:42256
    buffer_load_dwordx4 v11, s[8:11], s60 offen offset:1024 lds
    v_mfma_f32_16x16x32_bf16 v[120:123], a[8:11], v[148:151], v[120:123]
    ds_read_b64_tr_b16 v[172:173], v24 offset:40984
    s_addk_i32 s60, 18432
    s_mov_b32 s95, 0x00020000
    v_mfma_f32_16x16x32_bf16 v[124:127], a[12:15], v[148:151], v[124:127]
    ds_read_b64_tr_b16 v[174:175], v24 offset:42264
    buffer_load_dwordx4 v10, s[8:11], s60 offen offset:2048 lds
    s_waitcnt lgkmcnt(10)
    v_mfma_f32_16x16x32_bf16 v[128:131], a[8:11], v[152:155], v[128:131]
    ds_read_b64_tr_b16 v[144:145], v24 offset:40992
    ds_read_b128 a[24:27], v28 offset:16384
    s_mul_i32 s56, s35, 1280
    v_mfma_f32_16x16x32_bf16 v[132:135], a[12:15], v[152:155], v[132:135]
    ds_read_b64_tr_b16 v[146:147], v24 offset:42272
    ds_read_b128 a[28:31], v28 offset:18432
    v_mfma_f32_16x16x32_bf16 v[136:139], a[8:11], v[156:159], v[136:139]
    ds_read_b64_tr_b16 v[148:149], v24 offset:46080
    buffer_load_dwordx4 v11, s[8:11], s60 offen offset:3072 lds
    s_movk_i32 s57, 5120
    v_mfma_f32_16x16x32_bf16 v[140:143], a[12:15], v[156:159], v[140:143]
    ds_read_b64_tr_b16 v[150:151], v24 offset:47360
    s_add_u32 m0, s63, 143360
    s_waitcnt lgkmcnt(10)
    v_mfma_f32_16x16x32_bf16 v[64:67], v[160:163], a[16:19], v[64:67]
    ds_read_b64_tr_b16 v[152:153], v24 offset:46088
    s_mul_i32 s61, s55, 245760
    v_lshl_add_u32 v8, v3, 4, s56
    v_mfma_f32_16x16x32_bf16 v[68:71], v[160:163], a[20:23], v[68:71]
    ds_read_b64_tr_b16 v[154:155], v24 offset:47368
    s_add_u32 s61, s61, s64
    v_mfma_f32_16x16x32_bf16 v[72:75], v[164:167], a[16:19], v[72:75]
    ds_read_b64_tr_b16 v[156:157], v24 offset:46096
    buffer_load_dwordx4 v14, s[12:15], s61 offen offset:0 lds
    v_mad_u32_u24 v34, v2, s57, v8
    v_mfma_f32_16x16x32_bf16 v[76:79], v[164:167], a[20:23], v[76:79]
    ds_read_b64_tr_b16 v[158:159], v24 offset:47376
    s_waitcnt lgkmcnt(10)
    v_mfma_f32_16x16x32_bf16 v[80:83], v[168:171], a[16:19], v[80:83]
    ds_read_b64_tr_b16 v[160:161], v24 offset:46104
    s_lshl2_add_u32 s43, s43, s35
    v_add_u32 v32, 1024, v34
    v_mfma_f32_16x16x32_bf16 v[84:87], v[168:171], a[20:23], v[84:87]
    ds_read_b64_tr_b16 v[162:163], v24 offset:47384
    s_mulk_i32 s43, 13
    v_mfma_f32_16x16x32_bf16 v[88:91], v[172:175], a[16:19], v[88:91]
    ds_read_b64_tr_b16 v[164:165], v24 offset:46112
    buffer_load_dwordx4 v15, s[12:15], s61 offen offset:1024 lds
    v_and_b32 v8, 8, v3
    v_mfma_f32_16x16x32_bf16 v[92:95], v[172:175], a[20:23], v[92:95]
    ds_read_b64_tr_b16 v[166:167], v24 offset:47392
    s_waitcnt lgkmcnt(8)
    v_mfma_f32_16x16x32_bf16 v[96:99], v[144:147], a[16:19], v[96:99]
    ds_read_b64_tr_b16 v[168:169], v24 offset:51200
    v_min_u32 v217, 12, v1
    v_lshl_add_u32 v31, v8, 4, v34
    v_mfma_f32_16x16x32_bf16 v[100:103], v[144:147], a[20:23], v[100:103]
    ds_read_b64_tr_b16 v[170:171], v24 offset:52480
    v_add_u32 v217, s43, v217
    v_mfma_f32_16x16x32_bf16 v[104:107], a[16:19], v[148:151], v[104:107]
    ds_read_b64_tr_b16 v[172:173], v24 offset:51208
    v_lshlrev_b32 v217, 7, v217
    v_and_b32 v7, 3, v1
    v_mfma_f32_16x16x32_bf16 v[108:111], a[20:23], v[148:151], v[108:111]
    ds_read_b64_tr_b16 v[174:175], v24 offset:52488
    s_waitcnt lgkmcnt(8)
    v_mfma_f32_16x16x32_bf16 v[112:115], a[16:19], v[152:155], v[112:115]
    ds_read_b64_tr_b16 v[144:145], v24 offset:51216
    buffer_load_dwordx4 v16, s[12:15], s61 offen offset:2048 lds
    v_mad_u32_u24 v7, v2, 20, v7
    v_mfma_f32_16x16x32_bf16 v[116:119], a[20:23], v[152:155], v[116:119]
    ds_read_b64_tr_b16 v[146:147], v24 offset:52496
    v_mov_b32 v58, 0
    v_mfma_f32_16x16x32_bf16 v[120:123], a[16:19], v[156:159], v[120:123]
    ds_read_b64_tr_b16 v[148:149], v24 offset:51224
    v_lshl_add_u32 v7, v7, 4, s56
    v_mfma_f32_16x16x32_bf16 v[124:127], a[20:23], v[156:159], v[124:127]
    ds_read_b64_tr_b16 v[150:151], v24 offset:52504
    s_waitcnt lgkmcnt(8)
    v_mfma_f32_16x16x32_bf16 v[128:131], a[16:19], v[160:163], v[128:131]
    ds_read_b64_tr_b16 v[152:153], v24 offset:51232
    v_mad_u32_u24 v33, v6, s57, v7
    v_mfma_f32_16x16x32_bf16 v[132:135], a[20:23], v[160:163], v[132:135]
    ds_read_b64_tr_b16 v[154:155], v24 offset:52512
    buffer_load_dwordx4 v17, s[12:15], s61 offen offset:3072 lds
    v_mfma_f32_16x16x32_bf16 v[136:139], a[16:19], v[164:167], v[136:139]
    ds_read_b64_tr_b16 v[156:157], v24 offset:56320
    s_add_u32 m0, s63, 147456
    v_lshl_add_u32 v29, v6, 6, v33
    v_mfma_f32_16x16x32_bf16 v[140:143], a[20:23], v[164:167], v[140:143]
    ds_read_b64_tr_b16 v[158:159], v24 offset:57600
    s_waitcnt lgkmcnt(8)
    v_mfma_f32_16x16x32_bf16 v[64:67], v[168:171], a[24:27], v[64:67]
    ds_read_b64_tr_b16 v[160:161], v24 offset:56328
    v_add_u32 v53, 143360, v34
    v_mfma_f32_16x16x32_bf16 v[68:71], v[168:171], a[28:31], v[68:71]
    ds_read_b64_tr_b16 v[162:163], v24 offset:57608
    s_mov_b32 s40, 1051011932
    v_mfma_f32_16x16x32_bf16 v[72:75], v[172:175], a[24:27], v[72:75]
    ds_read_b64_tr_b16 v[164:165], v24 offset:56336
    buffer_load_dwordx4 v18, s[12:15], s61 offen lds
    v_mfma_f32_16x16x32_bf16 v[76:79], v[172:175], a[28:31], v[76:79]
    ds_read_b64_tr_b16 v[166:167], v24 offset:57616
    s_add_u32 m0, s62, 0
    s_waitcnt lgkmcnt(8)
    v_mfma_f32_16x16x32_bf16 v[80:83], v[144:147], a[24:27], v[80:83]
    ds_read_b64_tr_b16 v[168:169], v24 offset:56344
    s_bfe_u32 s55, s98, 0x40010
    s_mov_b32 s41, 1051011932
    v_mfma_f32_16x16x32_bf16 v[84:87], v[144:147], a[28:31], v[84:87]
    ds_read_b64_tr_b16 v[170:171], v24 offset:57624
    s_add_u32 s55, s55, s65
    v_mfma_f32_16x16x32_bf16 v[88:91], v[148:151], a[24:27], v[88:91]
    ds_read_b64_tr_b16 v[172:173], v24 offset:56352
    s_sub_u32 s60, s55, 10
    v_add_u32 v35, s63, v9
    v_mfma_f32_16x16x32_bf16 v[92:95], v[148:151], a[28:31], v[92:95]
    ds_read_b64_tr_b16 v[174:175], v24 offset:57632
    s_min_u32 s55, s55, s60
    s_waitcnt vmcnt(9)
    s_barrier
    s_waitcnt lgkmcnt(8)
    v_mfma_f32_16x16x32_bf16 v[96:99], v[152:155], a[24:27], v[96:99]
    ds_read_b64_tr_b16 v[144:145], v25 offset:0
    s_add_u32 s60, s55, s97
    ds_read_b128 a[32:35], v27 offset:32768
    v_add_u32 v57, 143360, v35
    v_mfma_f32_16x16x32_bf16 v[100:103], v[152:155], a[28:31], v[100:103]
    ds_read_b64_tr_b16 v[146:147], v25 offset:1280
    s_lshl_b32 s60, s60, 7
    v_mfma_f32_16x16x32_bf16 v[104:107], a[24:27], v[156:159], v[104:107]
    ds_read_b64_tr_b16 v[148:149], v25 offset:8
    buffer_load_dwordx4 v10, s[8:11], s60 offen offset:0 lds
    ds_read_b128 a[36:39], v27 offset:34816
    v_and_b32 v7, 7, v1
    v_mfma_f32_16x16x32_bf16 v[108:111], a[28:31], v[156:159], v[108:111]
    ds_read_b64_tr_b16 v[150:151], v25 offset:1288
    buffer_load_dwordx4 v11, s[8:11], s60 offen offset:1024 lds
    s_waitcnt lgkmcnt(10)
    v_mfma_f32_16x16x32_bf16 v[112:115], a[24:27], v[160:163], v[112:115]
    ds_read_b64_tr_b16 v[152:153], v25 offset:16
    s_addk_i32 s60, 18432
    v_lshl_add_u32 v7, v5, 3, v7
    v_mfma_f32_16x16x32_bf16 v[116:119], a[28:31], v[160:163], v[116:119]
    ds_read_b64_tr_b16 v[154:155], v25 offset:1296
    ds_read_b128 a[40:43], v28 offset:32768
    v_mfma_f32_16x16x32_bf16 v[120:123], a[24:27], v[164:167], v[120:123]
    ds_read_b64_tr_b16 v[156:157], v25 offset:24
    buffer_load_dwordx4 v10, s[8:11], s60 offen offset:2048 lds
    v_lshl_add_u32 v7, v7, 4, v8
    v_mfma_f32_16x16x32_bf16 v[124:127], a[28:31], v[164:167], v[124:127]
    ds_read_b64_tr_b16 v[158:159], v25 offset:1304
    s_waitcnt lgkmcnt(11)
    v_mfma_f32_16x16x32_bf16 v[128:131], a[24:27], v[168:171], v[128:131]
    ds_read_b64_tr_b16 v[160:161], v25 offset:32
    ds_read_b128 a[44:47], v28 offset:34816
    s_add_u32 s57, s63, 1024
    v_mfma_f32_16x16x32_bf16 v[132:135], a[28:31], v[168:171], v[132:135]
    ds_read_b64_tr_b16 v[162:163], v25 offset:1312
    v_add_u32 v36, s57, v7
    v_mfma_f32_16x16x32_bf16 v[136:139], a[24:27], v[172:175], v[136:139]
    ds_read_b64_tr_b16 v[164:165], v25 offset:5120
    buffer_load_dwordx4 v11, s[8:11], s60 offen offset:3072 lds
    v_mfma_f32_16x16x32_bf16 v[140:143], a[28:31], v[172:175], v[140:143]
    ds_read_b64_tr_b16 v[166:167], v25 offset:6400
    s_add_u32 m0, s63, 81920
    s_waitcnt lgkmcnt(10)
    v_mfma_f32_16x16x32_bf16 v[64:67], v[144:147], a[32:35], v[64:67]
    ds_read_b64_tr_b16 v[168:169], v25 offset:5128
    s_mul_i32 s61, s55, 245760
    s_add_u32 s57, s57, 143360
    v_mfma_f32_16x16x32_bf16 v[68:71], v[144:147], a[36:39], v[68:71]
    ds_read_b64_tr_b16 v[170:171], v25 offset:6408
    s_add_u32 s61, s61, s64
    v_mfma_f32_16x16x32_bf16 v[72:75], v[148:151], a[32:35], v[72:75]
    ds_read_b64_tr_b16 v[172:173], v25 offset:5136
    buffer_load_dwordx4 v14, s[12:15], s61 offen offset:0 lds
    v_lshl_add_u32 v7, v5, 3, s57
    v_mfma_f32_16x16x32_bf16 v[76:79], v[148:151], a[36:39], v[76:79]
    ds_read_b64_tr_b16 v[174:175], v25 offset:6416
    s_waitcnt lgkmcnt(9)
    v_mfma_f32_16x16x32_bf16 v[80:83], v[152:155], a[32:35], v[80:83]
    ds_read_b64_tr_b16 v[144:145], v25 offset:5144
    v_lshl_add_u32 v38, v3, 4, v7
    v_mfma_f32_16x16x32_bf16 v[84:87], v[152:155], a[36:39], v[84:87]
    ds_read_b64_tr_b16 v[146:147], v25 offset:6424
    s_movk_i32 s57, -192
    v_mfma_f32_16x16x32_bf16 v[88:91], v[156:159], a[32:35], v[88:91]
    ds_read_b64_tr_b16 v[148:149], v25 offset:5152
    buffer_load_dwordx4 v15, s[12:15], s61 offen offset:1024 lds
    v_mfma_f32_16x16x32_bf16 v[92:95], v[156:159], a[36:39], v[92:95]
    ds_read_b64_tr_b16 v[150:151], v25 offset:6432
    s_waitcnt lgkmcnt(8)
    v_mfma_f32_16x16x32_bf16 v[96:99], v[160:163], a[32:35], v[96:99]
    ds_read_b64_tr_b16 v[152:153], v25 offset:10240
    v_mad_i32_i24 v37, v4, s57, v35
    v_mfma_f32_16x16x32_bf16 v[100:103], v[160:163], a[36:39], v[100:103]
    ds_read_b64_tr_b16 v[154:155], v25 offset:11520
    s_lshl_b32 s57, s35, 6
    v_mfma_f32_16x16x32_bf16 v[104:107], a[32:35], v[164:167], v[104:107]
    ds_read_b64_tr_b16 v[156:157], v25 offset:10248
    v_add_u32 v30, s57, v37
    v_mfma_f32_16x16x32_bf16 v[108:111], a[36:39], v[164:167], v[108:111]
    ds_read_b64_tr_b16 v[158:159], v25 offset:11528
    s_waitcnt lgkmcnt(8)
    v_mfma_f32_16x16x32_bf16 v[112:115], a[32:35], v[168:171], v[112:115]
    ds_read_b64_tr_b16 v[160:161], v25 offset:10256
    buffer_load_dwordx4 v16, s[12:15], s61 offen offset:2048 lds
    v_mfma_f32_16x16x32_bf16 v[116:119], a[36:39], v[168:171], v[116:119]
    ds_read_b64_tr_b16 v[162:163], v25 offset:11536
    buffer_load_dword v221, v217, s[16:19], 0 offen
    buffer_load_dword v220, v63, s[24:27], 0 offen sc1
    buffer_load_dword v58, v58, s[28:31], 0 offen sc1
    v_mfma_f32_16x16x32_bf16 v[120:123], a[32:35], v[172:175], v[120:123]
    ds_read_b64_tr_b16 v[164:165], v25 offset:10264
    v_lshl_add_u32 v8, v4, 29, v36
    v_mfma_f32_16x16x32_bf16 v[124:127], a[36:39], v[172:175], v[124:127]
    ds_read_b64_tr_b16 v[166:167], v25 offset:11544
    s_waitcnt lgkmcnt(8)
    v_mfma_f32_16x16x32_bf16 v[128:131], a[32:35], v[144:147], v[128:131]
    ds_read_b64_tr_b16 v[168:169], v25 offset:10272
    s_sub_u32 s56, s69, 327680
    v_mfma_f32_16x16x32_bf16 v[132:135], a[36:39], v[144:147], v[132:135]
    ds_read_b64_tr_b16 v[170:171], v25 offset:11552
    buffer_load_dwordx4 v17, s[12:15], s61 offen offset:3072 lds
    v_mfma_f32_16x16x32_bf16 v[136:139], a[32:35], v[148:151], v[136:139]
    ds_read_b64_tr_b16 v[172:173], v25 offset:15360
    s_add_u32 m0, s63, 86016
    s_cmp_ge_u32 s33, 1
    s_cselect_b32 s56, s56, 1073741824
    v_mfma_f32_16x16x32_bf16 v[140:143], a[36:39], v[148:151], v[140:143]
    ds_read_b64_tr_b16 v[174:175], v25 offset:16640
    s_waitcnt lgkmcnt(8)
    v_mfma_f32_16x16x32_bf16 v[64:67], v[152:155], a[40:43], v[64:67]
    ds_read_b64_tr_b16 v[144:145], v25 offset:15368
    s_add_u32 s57, s56, 20480
    v_mfma_f32_16x16x32_bf16 v[68:71], v[152:155], a[44:47], v[68:71]
    ds_read_b64_tr_b16 v[146:147], v25 offset:16648
    v_add_u32 v39, s56, v35
    v_mfma_f32_16x16x32_bf16 v[72:75], v[156:159], a[40:43], v[72:75]
    ds_read_b64_tr_b16 v[148:149], v25 offset:15376
    buffer_load_dwordx4 v18, s[12:15], s61 offen lds
    v_mfma_f32_16x16x32_bf16 v[76:79], v[156:159], a[44:47], v[76:79]
    ds_read_b64_tr_b16 v[150:151], v25 offset:16656
    s_add_u32 m0, s62, 16384
    s_waitcnt lgkmcnt(8)
    v_mfma_f32_16x16x32_bf16 v[80:83], v[160:163], a[40:43], v[80:83]
    ds_read_b64_tr_b16 v[152:153], v25 offset:15384
    s_bfe_u32 s55, s98, 0x40014
    v_add_u32 v40, s56, v8
    v_mfma_f32_16x16x32_bf16 v[84:87], v[160:163], a[44:47], v[84:87]
    ds_read_b64_tr_b16 v[154:155], v25 offset:16664
    s_add_u32 s55, s55, s65
    v_mfma_f32_16x16x32_bf16 v[88:91], v[164:167], a[40:43], v[88:91]
    ds_read_b64_tr_b16 v[156:157], v25 offset:15392
    s_sub_u32 s60, s55, 10
    v_add_u32 v41, s57, v37
    v_mfma_f32_16x16x32_bf16 v[92:95], v[164:167], a[44:47], v[92:95]
    ds_read_b64_tr_b16 v[158:159], v25 offset:16672
    s_min_u32 s55, s55, s60
    s_waitcnt vmcnt(12)
    s_barrier
    s_waitcnt lgkmcnt(8)
    v_mfma_f32_16x16x32_bf16 v[96:99], v[168:171], a[40:43], v[96:99]
    ds_read_b64_tr_b16 v[160:161], v25 offset:20480
    s_add_u32 s60, s55, s97
    ds_read_b128 a[48:51], v27 offset:49152
    s_sub_u32 s56, s69, 655360
    v_mfma_f32_16x16x32_bf16 v[100:103], v[168:171], a[44:47], v[100:103]
    ds_read_b64_tr_b16 v[162:163], v25 offset:21760
    s_lshl_b32 s60, s60, 7
    v_mfma_f32_16x16x32_bf16 v[104:107], a[40:43], v[172:175], v[104:107]
    ds_read_b64_tr_b16 v[164:165], v25 offset:20488
    buffer_load_dwordx4 v10, s[8:11], s60 offen offset:0 lds
    ds_read_b128 a[52:55], v27 offset:51200
    s_cmp_ge_u32 s33, 2
    s_cselect_b32 s56, s56, 1073741824
    v_mfma_f32_16x16x32_bf16 v[108:111], a[44:47], v[172:175], v[108:111]
    ds_read_b64_tr_b16 v[166:167], v25 offset:21768
    buffer_load_dwordx4 v11, s[8:11], s60 offen offset:1024 lds
    s_waitcnt lgkmcnt(10)
    v_mfma_f32_16x16x32_bf16 v[112:115], a[40:43], v[144:147], v[112:115]
    ds_read_b64_tr_b16 v[168:169], v25 offset:20496
    s_addk_i32 s60, 18432
    s_add_u32 s57, s56, 20480
    v_mfma_f32_16x16x32_bf16 v[116:119], a[44:47], v[144:147], v[116:119]
    ds_read_b64_tr_b16 v[170:171], v25 offset:21776
    ds_read_b128 a[56:59], v28 offset:49152
    v_mfma_f32_16x16x32_bf16 v[120:123], a[40:43], v[148:151], v[120:123]
    ds_read_b64_tr_b16 v[172:173], v25 offset:20504
    buffer_load_dwordx4 v10, s[8:11], s60 offen offset:2048 lds
    v_add_u32 v42, s56, v35
    v_mfma_f32_16x16x32_bf16 v[124:127], a[44:47], v[148:151], v[124:127]
    ds_read_b64_tr_b16 v[174:175], v25 offset:21784
    s_waitcnt lgkmcnt(11)
    v_mfma_f32_16x16x32_bf16 v[128:131], a[40:43], v[152:155], v[128:131]
    ds_read_b64_tr_b16 v[144:145], v25 offset:20512
    ds_read_b128 a[60:63], v28 offset:51200
    v_add_u32 v43, s56, v8
    v_mfma_f32_16x16x32_bf16 v[132:135], a[44:47], v[152:155], v[132:135]
    ds_read_b64_tr_b16 v[146:147], v25 offset:21792
    v_add_u32 v44, s57, v37
    v_mfma_f32_16x16x32_bf16 v[136:139], a[40:43], v[156:159], v[136:139]
    ds_read_b64_tr_b16 v[148:149], v25 offset:25600
    buffer_load_dwordx4 v11, s[8:11], s60 offen offset:3072 lds
    v_mfma_f32_16x16x32_bf16 v[140:143], a[44:47], v[156:159], v[140:143]
    ds_read_b64_tr_b16 v[150:151], v25 offset:26880
    s_add_u32 m0, s63, 102400
    s_waitcnt lgkmcnt(10)
    v_mfma_f32_16x16x32_bf16 v[64:67], v[160:163], a[48:51], v[64:67]
    ds_read_b64_tr_b16 v[152:153], v25 offset:25608
    s_mul_i32 s61, s55, 245760
    v_xor_b32 v7, 31, v1
    v_mfma_f32_16x16x32_bf16 v[68:71], v[160:163], a[52:55], v[68:71]
    ds_read_b64_tr_b16 v[154:155], v25 offset:26888
    s_add_u32 s61, s61, s64
    v_mfma_f32_16x16x32_bf16 v[72:75], v[164:167], a[48:51], v[72:75]
    ds_read_b64_tr_b16 v[156:157], v25 offset:25616
    buffer_load_dwordx4 v14, s[12:15], s61 offen offset:0 lds
    v_lshrrev_b32 v7, v7, -1
    v_mfma_f32_16x16x32_bf16 v[76:79], v[164:167], a[52:55], v[76:79]
    ds_read_b64_tr_b16 v[158:159], v25 offset:26896
    s_waitcnt lgkmcnt(9)
    v_mfma_f32_16x16x32_bf16 v[80:83], v[168:171], a[48:51], v[80:83]
    ds_read_b64_tr_b16 v[160:161], v25 offset:25624
    v_lshlrev_b32 v8, 2, v4
    v_mfma_f32_16x16x32_bf16 v[84:87], v[168:171], a[52:55], v[84:87]
    ds_read_b64_tr_b16 v[162:163], v25 offset:26904
    v_lshrrev_b32 v7, v8, v7
    v_mfma_f32_16x16x32_bf16 v[88:91], v[172:175], a[48:51], v[88:91]
    ds_read_b64_tr_b16 v[164:165], v25 offset:25632
    buffer_load_dwordx4 v15, s[12:15], s61 offen offset:1024 lds
    v_mfma_f32_16x16x32_bf16 v[92:95], v[172:175], a[52:55], v[92:95]
    ds_read_b64_tr_b16 v[166:167], v25 offset:26912
    s_waitcnt lgkmcnt(8)
    v_mfma_f32_16x16x32_bf16 v[96:99], v[144:147], a[48:51], v[96:99]
    ds_read_b64_tr_b16 v[168:169], v25 offset:30720
    s_mov_b32 s38, 4048155338
    v_mfma_f32_16x16x32_bf16 v[100:103], v[144:147], a[52:55], v[100:103]
    ds_read_b64_tr_b16 v[170:171], v25 offset:32000
    v_bfe_i32 v8, v7, 0, 1
    v_mfma_f32_16x16x32_bf16 v[104:107], a[48:51], v[148:151], v[104:107]
    ds_read_b64_tr_b16 v[172:173], v25 offset:30728
    v_and_b32 v240, s38, v8
    v_mfma_f32_16x16x32_bf16 v[108:111], a[52:55], v[148:151], v[108:111]
    ds_read_b64_tr_b16 v[174:175], v25 offset:32008
    s_waitcnt lgkmcnt(8)
    v_mfma_f32_16x16x32_bf16 v[112:115], a[48:51], v[152:155], v[112:115]
    ds_read_b64_tr_b16 v[144:145], v25 offset:30736
    buffer_load_dwordx4 v16, s[12:15], s61 offen offset:2048 lds
    v_mfma_f32_16x16x32_bf16 v[116:119], a[52:55], v[152:155], v[116:119]
    ds_read_b64_tr_b16 v[146:147], v25 offset:32016
    v_bfe_i32 v8, v7, 1, 1
    v_mfma_f32_16x16x32_bf16 v[120:123], a[48:51], v[156:159], v[120:123]
    ds_read_b64_tr_b16 v[148:149], v25 offset:30744
    v_and_b32 v241, s38, v8
    v_mfma_f32_16x16x32_bf16 v[124:127], a[52:55], v[156:159], v[124:127]
    ds_read_b64_tr_b16 v[150:151], v25 offset:32024
    s_waitcnt lgkmcnt(8)
    v_mfma_f32_16x16x32_bf16 v[128:131], a[48:51], v[160:163], v[128:131]
    ds_read_b64_tr_b16 v[152:153], v25 offset:30752
    v_bfe_i32 v8, v7, 2, 1
    v_mfma_f32_16x16x32_bf16 v[132:135], a[52:55], v[160:163], v[132:135]
    ds_read_b64_tr_b16 v[154:155], v25 offset:32032
    buffer_load_dwordx4 v17, s[12:15], s61 offen offset:3072 lds
    v_mfma_f32_16x16x32_bf16 v[136:139], a[48:51], v[164:167], v[136:139]
    ds_read_b64_tr_b16 v[156:157], v25 offset:35840
    s_add_u32 m0, s63, 106496
    v_mfma_f32_16x16x32_bf16 v[140:143], a[52:55], v[164:167], v[140:143]
    ds_read_b64_tr_b16 v[158:159], v25 offset:37120
    s_waitcnt lgkmcnt(8)
    v_mfma_f32_16x16x32_bf16 v[64:67], v[168:171], a[56:59], v[64:67]
    ds_read_b64_tr_b16 v[160:161], v25 offset:35848
    v_and_b32 v242, s38, v8
    v_mfma_f32_16x16x32_bf16 v[68:71], v[168:171], a[60:63], v[68:71]
    ds_read_b64_tr_b16 v[162:163], v25 offset:37128
    v_bfe_i32 v8, v7, 3, 1
    v_mfma_f32_16x16x32_bf16 v[72:75], v[172:175], a[56:59], v[72:75]
    ds_read_b64_tr_b16 v[164:165], v25 offset:35856
    buffer_load_dwordx4 v18, s[12:15], s61 offen lds
    v_mfma_f32_16x16x32_bf16 v[76:79], v[172:175], a[60:63], v[76:79]
    ds_read_b64_tr_b16 v[166:167], v25 offset:37136
    s_add_u32 m0, s62, 32768
    s_waitcnt lgkmcnt(8)
    v_mfma_f32_16x16x32_bf16 v[80:83], v[144:147], a[56:59], v[80:83]
    ds_read_b64_tr_b16 v[168:169], v25 offset:35864
    s_bfe_u32 s55, s98, 0x40018
    v_and_b32 v243, s38, v8
    v_mfma_f32_16x16x32_bf16 v[84:87], v[144:147], a[60:63], v[84:87]
    ds_read_b64_tr_b16 v[170:171], v25 offset:37144
    s_add_u32 s55, s55, s65
    v_mfma_f32_16x16x32_bf16 v[88:91], v[148:151], a[56:59], v[88:91]
    ds_read_b64_tr_b16 v[172:173], v25 offset:35872
    s_sub_u32 s60, s55, 10
    v_bfe_i32 v8, v7, 16, 1
    v_mfma_f32_16x16x32_bf16 v[92:95], v[148:151], a[60:63], v[92:95]
    ds_read_b64_tr_b16 v[174:175], v25 offset:37152
    s_min_u32 s55, s55, s60
    v_and_b32 v244, s38, v8
    s_waitcnt vmcnt(9)
    s_barrier
    s_waitcnt lgkmcnt(8)
    v_mfma_f32_16x16x32_bf16 v[96:99], v[152:155], a[56:59], v[96:99]
    ds_read_b64_tr_b16 v[144:145], v24 offset:20480
    s_add_u32 s60, s55, s97
    ds_read_b128 a[64:67], v27 offset:0
    v_mfma_f32_16x16x32_bf16 v[100:103], v[152:155], a[60:63], v[100:103]
    ds_read_b64_tr_b16 v[146:147], v24 offset:21760
    s_lshl_b32 s60, s60, 7
    v_mfma_f32_16x16x32_bf16 v[104:107], a[56:59], v[156:159], v[104:107]
    ds_read_b64_tr_b16 v[148:149], v24 offset:20488
    buffer_load_dwordx4 v10, s[8:11], s60 offen offset:0 lds
    ds_read_b128 a[68:71], v27 offset:2048
    v_bfe_i32 v8, v7, 17, 1
    v_mfma_f32_16x16x32_bf16 v[108:111], a[60:63], v[156:159], v[108:111]
    ds_read_b64_tr_b16 v[150:151], v24 offset:21768
    buffer_load_dwordx4 v11, s[8:11], s60 offen offset:1024 lds
    s_waitcnt lgkmcnt(10)
    v_mfma_f32_16x16x32_bf16 v[112:115], a[56:59], v[160:163], v[112:115]
    ds_read_b64_tr_b16 v[152:153], v24 offset:20496
    s_addk_i32 s60, 18432
    v_and_b32 v245, s38, v8
    v_mfma_f32_16x16x32_bf16 v[116:119], a[60:63], v[160:163], v[116:119]
    ds_read_b64_tr_b16 v[154:155], v24 offset:21776
    ds_read_b128 a[72:75], v28 offset:0
    v_mfma_f32_16x16x32_bf16 v[120:123], a[56:59], v[164:167], v[120:123]
    ds_read_b64_tr_b16 v[156:157], v24 offset:20504
    buffer_load_dwordx4 v10, s[8:11], s60 offen offset:2048 lds
    v_bfe_i32 v8, v7, 18, 1
    v_mfma_f32_16x16x32_bf16 v[124:127], a[60:63], v[164:167], v[124:127]
    ds_read_b64_tr_b16 v[158:159], v24 offset:21784
    s_waitcnt lgkmcnt(11)
    v_mfma_f32_16x16x32_bf16 v[128:131], a[56:59], v[168:171], v[128:131]
    ds_read_b64_tr_b16 v[160:161], v24 offset:20512
    ds_read_b128 a[76:79], v28 offset:2048
    v_and_b32 v246, s38, v8
    v_mfma_f32_16x16x32_bf16 v[132:135], a[60:63], v[168:171], v[132:135]
    ds_read_b64_tr_b16 v[162:163], v24 offset:21792
    v_bfe_i32 v8, v7, 19, 1
    v_mfma_f32_16x16x32_bf16 v[136:139], a[56:59], v[172:175], v[136:139]
    ds_read_b64_tr_b16 v[164:165], v24 offset:25600
    buffer_load_dwordx4 v11, s[8:11], s60 offen offset:3072 lds
    v_mfma_f32_16x16x32_bf16 v[140:143], a[60:63], v[172:175], v[140:143]
    ds_read_b64_tr_b16 v[166:167], v24 offset:26880
    s_add_u32 m0, s63, 122880
    s_waitcnt lgkmcnt(10)
    v_mfma_f32_16x16x32_bf16 v[64:67], v[144:147], a[64:67], v[64:67]
    ds_read_b64_tr_b16 v[168:169], v24 offset:25608
    s_mul_i32 s61, s55, 245760
    v_and_b32 v247, s38, v8
    v_mfma_f32_16x16x32_bf16 v[68:71], v[144:147], a[68:71], v[68:71]
    ds_read_b64_tr_b16 v[170:171], v24 offset:26888
    s_add_u32 s61, s61, s64
    v_mfma_f32_16x16x32_bf16 v[72:75], v[148:151], a[64:67], v[72:75]
    ds_read_b64_tr_b16 v[172:173], v24 offset:25616
    buffer_load_dwordx4 v14, s[12:15], s61 offen offset:0 lds
    v_bfe_i32 v8, v7, 8, 1
    v_mfma_f32_16x16x32_bf16 v[76:79], v[148:151], a[68:71], v[76:79]
    ds_read_b64_tr_b16 v[174:175], v24 offset:26896
    s_waitcnt lgkmcnt(9)
    v_mfma_f32_16x16x32_bf16 v[80:83], v[152:155], a[64:67], v[80:83]
    ds_read_b64_tr_b16 v[144:145], v24 offset:25624
    v_and_b32 v248, s38, v8
    v_mfma_f32_16x16x32_bf16 v[84:87], v[152:155], a[68:71], v[84:87]
    ds_read_b64_tr_b16 v[146:147], v24 offset:26904
    v_bfe_i32 v8, v7, 9, 1
    v_mfma_f32_16x16x32_bf16 v[88:91], v[156:159], a[64:67], v[88:91]
    ds_read_b64_tr_b16 v[148:149], v24 offset:25632
    buffer_load_dwordx4 v15, s[12:15], s61 offen offset:1024 lds
    v_mfma_f32_16x16x32_bf16 v[92:95], v[156:159], a[68:71], v[92:95]
    ds_read_b64_tr_b16 v[150:151], v24 offset:26912
    v_and_b32 v249, s38, v8
    s_waitcnt lgkmcnt(8)
    v_mfma_f32_16x16x32_bf16 v[96:99], v[160:163], a[64:67], v[96:99]
    ds_read_b64_tr_b16 v[152:153], v24 offset:30720
    v_bfe_i32 v8, v7, 10, 1
    v_mfma_f32_16x16x32_bf16 v[100:103], v[160:163], a[68:71], v[100:103]
    ds_read_b64_tr_b16 v[154:155], v24 offset:32000
    v_and_b32 v250, s38, v8
    v_mfma_f32_16x16x32_bf16 v[104:107], a[64:67], v[164:167], v[104:107]
    ds_read_b64_tr_b16 v[156:157], v24 offset:30728
    v_bfe_i32 v8, v7, 11, 1
    v_mfma_f32_16x16x32_bf16 v[108:111], a[68:71], v[164:167], v[108:111]
    ds_read_b64_tr_b16 v[158:159], v24 offset:32008
    s_waitcnt lgkmcnt(8)
    v_mfma_f32_16x16x32_bf16 v[112:115], a[64:67], v[168:171], v[112:115]
    ds_read_b64_tr_b16 v[160:161], v24 offset:30736
    buffer_load_dwordx4 v16, s[12:15], s61 offen offset:2048 lds
    v_mfma_f32_16x16x32_bf16 v[116:119], a[68:71], v[168:171], v[116:119]
    ds_read_b64_tr_b16 v[162:163], v24 offset:32016
    v_and_b32 v251, s38, v8
    v_mfma_f32_16x16x32_bf16 v[120:123], a[64:67], v[172:175], v[120:123]
    ds_read_b64_tr_b16 v[164:165], v24 offset:30744
    v_bfe_i32 v8, v7, 24, 1
    v_mfma_f32_16x16x32_bf16 v[124:127], a[68:71], v[172:175], v[124:127]
    ds_read_b64_tr_b16 v[166:167], v24 offset:32024
    s_waitcnt lgkmcnt(8)
    v_mfma_f32_16x16x32_bf16 v[128:131], a[64:67], v[144:147], v[128:131]
    ds_read_b64_tr_b16 v[168:169], v24 offset:30752
    v_and_b32 v252, s38, v8
    v_mfma_f32_16x16x32_bf16 v[132:135], a[68:71], v[144:147], v[132:135]
    ds_read_b64_tr_b16 v[170:171], v24 offset:32032
    buffer_load_dwordx4 v17, s[12:15], s61 offen offset:3072 lds
    v_mfma_f32_16x16x32_bf16 v[136:139], a[64:67], v[148:151], v[136:139]
    ds_read_b64_tr_b16 v[172:173], v24 offset:35840
    s_add_u32 m0, s63, 126976
    v_mfma_f32_16x16x32_bf16 v[140:143], a[68:71], v[148:151], v[140:143]
    ds_read_b64_tr_b16 v[174:175], v24 offset:37120
    s_waitcnt lgkmcnt(8)
    v_mfma_f32_16x16x32_bf16 v[64:67], v[152:155], a[72:75], v[64:67]
    ds_read_b64_tr_b16 v[144:145], v24 offset:35848
    v_bfe_i32 v8, v7, 25, 1
    v_mfma_f32_16x16x32_bf16 v[68:71], v[152:155], a[76:79], v[68:71]
    ds_read_b64_tr_b16 v[146:147], v24 offset:37128
    v_and_b32 v253, s38, v8
    v_mfma_f32_16x16x32_bf16 v[72:75], v[156:159], a[72:75], v[72:75]
    ds_read_b64_tr_b16 v[148:149], v24 offset:35856
    buffer_load_dwordx4 v18, s[12:15], s61 offen lds
    v_mfma_f32_16x16x32_bf16 v[76:79], v[156:159], a[76:79], v[76:79]
    ds_read_b64_tr_b16 v[150:151], v24 offset:37136
    s_add_u32 m0, s62, 49152
    s_waitcnt lgkmcnt(8)
    v_mfma_f32_16x16x32_bf16 v[80:83], v[160:163], a[72:75], v[80:83]
    ds_read_b64_tr_b16 v[152:153], v24 offset:35864
    s_bfe_u32 s55, s98, 0x4001c
    v_mfma_f32_16x16x32_bf16 v[84:87], v[160:163], a[76:79], v[84:87]
    ds_read_b64_tr_b16 v[154:155], v24 offset:37144
    s_add_u32 s55, s55, s65
    v_mfma_f32_16x16x32_bf16 v[88:91], v[164:167], a[72:75], v[88:91]
    ds_read_b64_tr_b16 v[156:157], v24 offset:35872
    s_sub_u32 s60, s55, 10
    v_bfe_i32 v8, v7, 26, 1
    v_mfma_f32_16x16x32_bf16 v[92:95], v[164:167], a[76:79], v[92:95]
    ds_read_b64_tr_b16 v[158:159], v24 offset:37152
    s_min_u32 s55, s55, s60
    s_waitcnt vmcnt(9)
    s_barrier
    s_waitcnt lgkmcnt(8)
    v_mfma_f32_16x16x32_bf16 v[96:99], v[168:171], a[72:75], v[96:99]
    ds_read_b64_tr_b16 v[160:161], v24 offset:40960
    s_add_u32 s60, s55, s97
    ds_read_b128 a[80:83], v27 offset:16384
    v_and_b32 v254, s38, v8
    v_mfma_f32_16x16x32_bf16 v[100:103], v[168:171], a[76:79], v[100:103]
    ds_read_b64_tr_b16 v[162:163], v24 offset:42240
    s_lshl_b32 s60, s60, 7
    v_mfma_f32_16x16x32_bf16 v[104:107], a[72:75], v[172:175], v[104:107]
    ds_read_b64_tr_b16 v[164:165], v24 offset:40968
    buffer_load_dwordx4 v10, s[8:11], s60 offen offset:0 lds
    ds_read_b128 a[84:87], v27 offset:18432
    v_bfe_i32 v8, v7, 27, 1
    v_mfma_f32_16x16x32_bf16 v[108:111], a[76:79], v[172:175], v[108:111]
    ds_read_b64_tr_b16 v[166:167], v24 offset:42248
    buffer_load_dwordx4 v11, s[8:11], s60 offen offset:1024 lds
    s_waitcnt lgkmcnt(10)
    v_mfma_f32_16x16x32_bf16 v[112:115], a[72:75], v[144:147], v[112:115]
    ds_read_b64_tr_b16 v[168:169], v24 offset:40976
    s_addk_i32 s60, 18432
    v_and_b32 v255, s38, v8
    v_mfma_f32_16x16x32_bf16 v[116:119], a[76:79], v[144:147], v[116:119]
    ds_read_b64_tr_b16 v[170:171], v24 offset:42256
    ds_read_b128 a[88:91], v28 offset:16384
    v_mfma_f32_16x16x32_bf16 v[120:123], a[72:75], v[148:151], v[120:123]
    ds_read_b64_tr_b16 v[172:173], v24 offset:40984
    buffer_load_dwordx4 v10, s[8:11], s60 offen offset:2048 lds
    s_mov_b32 s0, 40960
    v_mfma_f32_16x16x32_bf16 v[124:127], a[76:79], v[148:151], v[124:127]
    ds_read_b64_tr_b16 v[174:175], v24 offset:42264
    s_waitcnt lgkmcnt(11)
    v_mfma_f32_16x16x32_bf16 v[128:131], a[72:75], v[152:155], v[128:131]
    ds_read_b64_tr_b16 v[144:145], v24 offset:40992
    ds_read_b128 a[92:95], v28 offset:18432
    s_mov_b32 s1, 81920
    v_mfma_f32_16x16x32_bf16 v[132:135], a[76:79], v[152:155], v[132:135]
    ds_read_b64_tr_b16 v[146:147], v24 offset:42272
    s_mov_b32 s53, 122880
    v_mfma_f32_16x16x32_bf16 v[136:139], a[72:75], v[156:159], v[136:139]
    ds_read_b64_tr_b16 v[148:149], v24 offset:46080
    buffer_load_dwordx4 v11, s[8:11], s60 offen offset:3072 lds
    v_mfma_f32_16x16x32_bf16 v[140:143], a[76:79], v[156:159], v[140:143]
    ds_read_b64_tr_b16 v[150:151], v24 offset:47360
    s_add_u32 m0, s63, 143360
    s_waitcnt lgkmcnt(10)
    v_mfma_f32_16x16x32_bf16 v[64:67], v[160:163], a[80:83], v[64:67]
    ds_read_b64_tr_b16 v[152:153], v24 offset:46088
    s_mul_i32 s61, s55, 245760
    s_mov_b32 s44, 0x000FFFFF
    v_mfma_f32_16x16x32_bf16 v[68:71], v[160:163], a[84:87], v[68:71]
    ds_read_b64_tr_b16 v[154:155], v24 offset:47368
    s_add_u32 s61, s61, s64
    v_mfma_f32_16x16x32_bf16 v[72:75], v[164:167], a[80:83], v[72:75]
    ds_read_b64_tr_b16 v[156:157], v24 offset:46096
    buffer_load_dwordx4 v14, s[12:15], s61 offen offset:0 lds
    s_mov_b32 s45, 0x000FFFFF
    v_mfma_f32_16x16x32_bf16 v[76:79], v[164:167], a[84:87], v[76:79]
    ds_read_b64_tr_b16 v[158:159], v24 offset:47376
    s_waitcnt lgkmcnt(9)
    v_mfma_f32_16x16x32_bf16 v[80:83], v[168:171], a[80:83], v[80:83]
    ds_read_b64_tr_b16 v[160:161], v24 offset:46104
    s_mov_b32 s6, 813694976
    v_mfma_f32_16x16x32_bf16 v[84:87], v[168:171], a[84:87], v[84:87]
    ds_read_b64_tr_b16 v[162:163], v24 offset:47384
    s_mov_b32 s7, 1317011456
    v_mfma_f32_16x16x32_bf16 v[88:91], v[172:175], a[80:83], v[88:91]
    ds_read_b64_tr_b16 v[164:165], v24 offset:46112
    buffer_load_dwordx4 v15, s[12:15], s61 offen offset:1024 lds
    v_mfma_f32_16x16x32_bf16 v[92:95], v[172:175], a[84:87], v[92:95]
    ds_read_b64_tr_b16 v[166:167], v24 offset:47392
    s_waitcnt lgkmcnt(8)
    v_mfma_f32_16x16x32_bf16 v[96:99], v[144:147], a[80:83], v[96:99]
    ds_read_b64_tr_b16 v[168:169], v24 offset:51200
    s_lshr_b32 s58, s34, 1
    v_mfma_f32_16x16x32_bf16 v[100:103], v[144:147], a[84:87], v[100:103]
    ds_read_b64_tr_b16 v[170:171], v24 offset:52480
    s_add_u32 s56, s58, s33
    v_mfma_f32_16x16x32_bf16 v[104:107], a[80:83], v[148:151], v[104:107]
    ds_read_b64_tr_b16 v[172:173], v24 offset:51208
    s_and_b32 s3, s56, 3
    v_mfma_f32_16x16x32_bf16 v[108:111], a[84:87], v[148:151], v[108:111]
    ds_read_b64_tr_b16 v[174:175], v24 offset:52488
    s_waitcnt lgkmcnt(8)
    v_mfma_f32_16x16x32_bf16 v[112:115], a[80:83], v[152:155], v[112:115]
    ds_read_b64_tr_b16 v[144:145], v24 offset:51216
    buffer_load_dwordx4 v16, s[12:15], s61 offen offset:2048 lds
    v_mfma_f32_16x16x32_bf16 v[116:119], a[84:87], v[152:155], v[116:119]
    ds_read_b64_tr_b16 v[146:147], v24 offset:52496
    s_lshl2_add_u32 s56, s3, s3
    v_mfma_f32_16x16x32_bf16 v[120:123], a[80:83], v[156:159], v[120:123]
    ds_read_b64_tr_b16 v[148:149], v24 offset:51224
    s_add_u32 s56, s56, s35
    v_mfma_f32_16x16x32_bf16 v[124:127], a[84:87], v[156:159], v[124:127]
    ds_read_b64_tr_b16 v[150:151], v24 offset:52504
    s_waitcnt lgkmcnt(8)
    v_mfma_f32_16x16x32_bf16 v[128:131], a[80:83], v[160:163], v[128:131]
    ds_read_b64_tr_b16 v[152:153], v24 offset:51232
    s_mul_i32 s56, s56, 40960
    v_mfma_f32_16x16x32_bf16 v[132:135], a[84:87], v[160:163], v[132:135]
    ds_read_b64_tr_b16 v[154:155], v24 offset:52512
    buffer_load_dwordx4 v17, s[12:15], s61 offen offset:3072 lds
    v_mfma_f32_16x16x32_bf16 v[136:139], a[80:83], v[164:167], v[136:139]
    ds_read_b64_tr_b16 v[156:157], v24 offset:56320
    s_add_u32 m0, s63, 147456
    v_mfma_f32_16x16x32_bf16 v[140:143], a[84:87], v[164:167], v[140:143]
    ds_read_b64_tr_b16 v[158:159], v24 offset:57600
    s_waitcnt lgkmcnt(8)
    v_mfma_f32_16x16x32_bf16 v[64:67], v[168:171], a[88:91], v[64:67]
    ds_read_b64_tr_b16 v[160:161], v24 offset:56328
    s_add_u32 s4, s56, s47
    v_mfma_f32_16x16x32_bf16 v[68:71], v[168:171], a[92:95], v[68:71]
    ds_read_b64_tr_b16 v[162:163], v24 offset:57608
    s_add_u32 s5, s4, 163840
    v_mfma_f32_16x16x32_bf16 v[72:75], v[172:175], a[88:91], v[72:75]
    ds_read_b64_tr_b16 v[164:165], v24 offset:56336
    buffer_load_dwordx4 v18, s[12:15], s61 offen lds
    v_mfma_f32_16x16x32_bf16 v[76:79], v[172:175], a[92:95], v[76:79]
    ds_read_b64_tr_b16 v[166:167], v24 offset:57616
    s_add_u32 m0, s62, 0
    s_waitcnt lgkmcnt(8)
    v_mfma_f32_16x16x32_bf16 v[80:83], v[144:147], a[88:91], v[80:83]
    ds_read_b64_tr_b16 v[168:169], v24 offset:56344
    s_bfe_u32 s55, s99, 0x40000
    s_sub_u32 s56, s5, 819200
    v_mfma_f32_16x16x32_bf16 v[84:87], v[144:147], a[92:95], v[84:87]
    ds_read_b64_tr_b16 v[170:171], v24 offset:57624
    s_add_u32 s55, s55, s65
    v_mfma_f32_16x16x32_bf16 v[88:91], v[148:151], a[88:91], v[88:91]
    ds_read_b64_tr_b16 v[172:173], v24 offset:56352
    s_sub_u32 s60, s55, 10
    s_min_u32 s5, s5, s56
    v_mfma_f32_16x16x32_bf16 v[92:95], v[148:151], a[92:95], v[92:95]
    ds_read_b64_tr_b16 v[174:175], v24 offset:57632
    s_min_u32 s55, s55, s60
    s_waitcnt vmcnt(9)
    s_barrier
    s_waitcnt lgkmcnt(8)
    v_mfma_f32_16x16x32_bf16 v[96:99], v[152:155], a[88:91], v[96:99]
    ds_read_b64_tr_b16 v[144:145], v25 offset:0
    s_add_u32 s60, s55, s97
    ds_read_b128 a[96:99], v27 offset:32768
    s_add_u32 s100, s4, 327680
    v_mfma_f32_16x16x32_bf16 v[100:103], v[152:155], a[92:95], v[100:103]
    ds_read_b64_tr_b16 v[146:147], v25 offset:1280
    s_lshl_b32 s60, s60, 7
    v_mfma_f32_16x16x32_bf16 v[104:107], a[88:91], v[156:159], v[104:107]
    ds_read_b64_tr_b16 v[148:149], v25 offset:8
    buffer_load_dwordx4 v10, s[8:11], s60 offen offset:0 lds
    ds_read_b128 a[100:103], v27 offset:34816
    s_sub_u32 s56, s100, 819200
    v_mfma_f32_16x16x32_bf16 v[108:111], a[92:95], v[156:159], v[108:111]
    ds_read_b64_tr_b16 v[150:151], v25 offset:1288
    buffer_load_dwordx4 v11, s[8:11], s60 offen offset:1024 lds
    s_waitcnt lgkmcnt(10)
    v_mfma_f32_16x16x32_bf16 v[112:115], a[88:91], v[160:163], v[112:115]
    ds_read_b64_tr_b16 v[152:153], v25 offset:16
    s_addk_i32 s60, 18432
    s_min_u32 s100, s100, s56
    v_mfma_f32_16x16x32_bf16 v[116:119], a[92:95], v[160:163], v[116:119]
    ds_read_b64_tr_b16 v[154:155], v25 offset:1296
    ds_read_b128 a[104:107], v28 offset:32768
    v_mfma_f32_16x16x32_bf16 v[120:123], a[88:91], v[164:167], v[120:123]
    ds_read_b64_tr_b16 v[156:157], v25 offset:24
    buffer_load_dwordx4 v10, s[8:11], s60 offen offset:2048 lds
    s_add_u32 s101, s4, 491520
    v_mfma_f32_16x16x32_bf16 v[124:127], a[92:95], v[164:167], v[124:127]
    ds_read_b64_tr_b16 v[158:159], v25 offset:1304
    s_waitcnt lgkmcnt(11)
    v_mfma_f32_16x16x32_bf16 v[128:131], a[88:91], v[168:171], v[128:131]
    ds_read_b64_tr_b16 v[160:161], v25 offset:32
    ds_read_b128 a[108:111], v28 offset:34816
    s_sub_u32 s56, s101, 819200
    v_mfma_f32_16x16x32_bf16 v[132:135], a[92:95], v[168:171], v[132:135]
    ds_read_b64_tr_b16 v[162:163], v25 offset:1312
    s_min_u32 s101, s101, s56
    v_mfma_f32_16x16x32_bf16 v[136:139], a[88:91], v[172:175], v[136:139]
    ds_read_b64_tr_b16 v[164:165], v25 offset:5120
    buffer_load_dwordx4 v11, s[8:11], s60 offen offset:3072 lds
    v_mfma_f32_16x16x32_bf16 v[140:143], a[92:95], v[172:175], v[140:143]
    ds_read_b64_tr_b16 v[166:167], v25 offset:6400
    s_add_u32 m0, s63, 81920
    s_waitcnt lgkmcnt(10)
    v_mfma_f32_16x16x32_bf16 v[64:67], v[144:147], a[96:99], v[64:67]
    ds_read_b64_tr_b16 v[168:169], v25 offset:5128
    s_mul_i32 s61, s55, 245760
    s_add_u32 s67, s4, 655360
    v_mfma_f32_16x16x32_bf16 v[68:71], v[144:147], a[100:103], v[68:71]
    ds_read_b64_tr_b16 v[170:171], v25 offset:6408
    s_add_u32 s61, s61, s64
    v_mfma_f32_16x16x32_bf16 v[72:75], v[148:151], a[96:99], v[72:75]
    ds_read_b64_tr_b16 v[172:173], v25 offset:5136
    buffer_load_dwordx4 v14, s[12:15], s61 offen offset:0 lds
    s_sub_u32 s56, s67, 819200
    v_mfma_f32_16x16x32_bf16 v[76:79], v[148:151], a[100:103], v[76:79]
    ds_read_b64_tr_b16 v[174:175], v25 offset:6416
    s_waitcnt lgkmcnt(9)
    v_mfma_f32_16x16x32_bf16 v[80:83], v[152:155], a[96:99], v[80:83]
    ds_read_b64_tr_b16 v[144:145], v25 offset:5144
    s_min_u32 s67, s67, s56
    v_mfma_f32_16x16x32_bf16 v[84:87], v[152:155], a[100:103], v[84:87]
    ds_read_b64_tr_b16 v[146:147], v25 offset:6424
    s_mul_i32 s58, s58, 5120
    v_mfma_f32_16x16x32_bf16 v[88:91], v[156:159], a[96:99], v[88:91]
    ds_read_b64_tr_b16 v[148:149], v25 offset:5152
    buffer_load_dwordx4 v15, s[12:15], s61 offen offset:1024 lds
    v_mfma_f32_16x16x32_bf16 v[92:95], v[156:159], a[100:103], v[92:95]
    ds_read_b64_tr_b16 v[150:151], v25 offset:6432
    s_waitcnt lgkmcnt(8)
    v_mfma_f32_16x16x32_bf16 v[96:99], v[160:163], a[96:99], v[96:99]
    ds_read_b64_tr_b16 v[152:153], v25 offset:10240
    s_add_u32 s58, s58, s36
    v_mfma_f32_16x16x32_bf16 v[100:103], v[160:163], a[100:103], v[100:103]
    ds_read_b64_tr_b16 v[154:155], v25 offset:11520
    s_and_b32 s57, s34, 1
    v_mfma_f32_16x16x32_bf16 v[104:107], a[96:99], v[164:167], v[104:107]
    ds_read_b64_tr_b16 v[156:157], v25 offset:10248
    s_lshl2_add_u32 s57, s57, s35
    v_mfma_f32_16x16x32_bf16 v[108:111], a[100:103], v[164:167], v[108:111]
    ds_read_b64_tr_b16 v[158:159], v25 offset:11528
    s_waitcnt lgkmcnt(8)
    v_mfma_f32_16x16x32_bf16 v[112:115], a[96:99], v[168:171], v[112:115]
    ds_read_b64_tr_b16 v[160:161], v25 offset:10256
    buffer_load_dwordx4 v16, s[12:15], s61 offen offset:2048 lds
    v_mfma_f32_16x16x32_bf16 v[116:119], a[100:103], v[168:171], v[116:119]
    ds_read_b64_tr_b16 v[162:163], v25 offset:11536
    s_lshl_b32 s57, s57, 7
    v_mfma_f32_16x16x32_bf16 v[120:123], a[96:99], v[172:175], v[120:123]
    ds_read_b64_tr_b16 v[164:165], v25 offset:10264
    s_lshl2_add_u32 s56, s57, s58
    v_mfma_f32_16x16x32_bf16 v[124:127], a[100:103], v[172:175], v[124:127]
    ds_read_b64_tr_b16 v[166:167], v25 offset:11544
    s_waitcnt lgkmcnt(8)
    v_mfma_f32_16x16x32_bf16 v[128:131], a[96:99], v[144:147], v[128:131]
    ds_read_b64_tr_b16 v[168:169], v25 offset:10272
    v_mul_u32_u24 v8, 20480, v5
    v_mfma_f32_16x16x32_bf16 v[132:135], a[100:103], v[144:147], v[132:135]
    ds_read_b64_tr_b16 v[170:171], v25 offset:11552
    buffer_load_dwordx4 v17, s[12:15], s61 offen offset:3072 lds
    v_mfma_f32_16x16x32_bf16 v[136:139], a[96:99], v[148:151], v[136:139]
    ds_read_b64_tr_b16 v[172:173], v25 offset:15360
    s_add_u32 m0, s63, 86016
    v_mfma_f32_16x16x32_bf16 v[140:143], a[100:103], v[148:151], v[140:143]
    ds_read_b64_tr_b16 v[174:175], v25 offset:16640
    s_waitcnt lgkmcnt(8)
    v_mfma_f32_16x16x32_bf16 v[64:67], v[152:155], a[104:107], v[64:67]
    ds_read_b64_tr_b16 v[144:145], v25 offset:15368
    v_lshl_add_u32 v7, v4, 4, v3
    v_mfma_f32_16x16x32_bf16 v[68:71], v[152:155], a[108:111], v[68:71]
    ds_read_b64_tr_b16 v[146:147], v25 offset:16648
    v_lshl_add_u32 v7, v7, 4, s56
    v_mfma_f32_16x16x32_bf16 v[72:75], v[156:159], a[104:107], v[72:75]
    ds_read_b64_tr_b16 v[148:149], v25 offset:15376
    buffer_load_dwordx4 v18, s[12:15], s61 offen lds
    v_mfma_f32_16x16x32_bf16 v[76:79], v[156:159], a[108:111], v[76:79]
    ds_read_b64_tr_b16 v[150:151], v25 offset:16656
    s_add_u32 m0, s62, 16384
    s_waitcnt lgkmcnt(8)
    v_mfma_f32_16x16x32_bf16 v[80:83], v[160:163], a[104:107], v[80:83]
    ds_read_b64_tr_b16 v[152:153], v25 offset:15384
    s_bfe_u32 s55, s99, 0x40004
    v_add_u32 v46, v7, v8
    v_mfma_f32_16x16x32_bf16 v[84:87], v[160:163], a[108:111], v[84:87]
    ds_read_b64_tr_b16 v[154:155], v25 offset:16664
    s_add_u32 s55, s55, s65
    v_mfma_f32_16x16x32_bf16 v[88:91], v[164:167], a[104:107], v[88:91]
    ds_read_b64_tr_b16 v[156:157], v25 offset:15392
    s_sub_u32 s60, s55, 10
    s_add_u32 s56, s57, s58
    v_mfma_f32_16x16x32_bf16 v[92:95], v[164:167], a[108:111], v[92:95]
    ds_read_b64_tr_b16 v[158:159], v25 offset:16672
    s_min_u32 s55, s55, s60
    s_waitcnt vmcnt(9)
    s_barrier
    s_waitcnt lgkmcnt(8)
    v_mfma_f32_16x16x32_bf16 v[96:99], v[168:171], a[104:107], v[96:99]
    ds_read_b64_tr_b16 v[160:161], v25 offset:20480
    s_add_u32 s60, s55, s97
    ds_read_b128 a[112:115], v27 offset:49152
    s_addk_i32 s56, 4096
    v_mfma_f32_16x16x32_bf16 v[100:103], v[168:171], a[108:111], v[100:103]
    ds_read_b64_tr_b16 v[162:163], v25 offset:21760
    s_lshl_b32 s60, s60, 7
    v_mfma_f32_16x16x32_bf16 v[104:107], a[104:107], v[172:175], v[104:107]
    ds_read_b64_tr_b16 v[164:165], v25 offset:20488
    buffer_load_dwordx4 v10, s[8:11], s60 offen offset:0 lds
    ds_read_b128 a[116:119], v27 offset:51200
    v_lshl_add_u32 v7, v4, 27, v3
    v_mfma_f32_16x16x32_bf16 v[108:111], a[108:111], v[172:175], v[108:111]
    ds_read_b64_tr_b16 v[166:167], v25 offset:21768
    buffer_load_dwordx4 v11, s[8:11], s60 offen offset:1024 lds
    s_waitcnt lgkmcnt(10)
    v_mfma_f32_16x16x32_bf16 v[112:115], a[104:107], v[144:147], v[112:115]
    ds_read_b64_tr_b16 v[168:169], v25 offset:20496
    s_addk_i32 s60, 18432
    v_lshl_add_u32 v7, v7, 3, s56
    v_mfma_f32_16x16x32_bf16 v[116:119], a[108:111], v[144:147], v[116:119]
    ds_read_b64_tr_b16 v[170:171], v25 offset:21776
    ds_read_b128 a[120:123], v28 offset:49152
    v_mfma_f32_16x16x32_bf16 v[120:123], a[104:107], v[148:151], v[120:123]
    ds_read_b64_tr_b16 v[172:173], v25 offset:20504
    buffer_load_dwordx4 v10, s[8:11], s60 offen offset:2048 lds
    v_add_u32 v47, v7, v8
    v_mfma_f32_16x16x32_bf16 v[124:127], a[108:111], v[148:151], v[124:127]
    ds_read_b64_tr_b16 v[174:175], v25 offset:21784
    s_mul_i32 s56, s37, 20480
    s_waitcnt lgkmcnt(11)
    v_mfma_f32_16x16x32_bf16 v[128:131], a[104:107], v[152:155], v[128:131]
    ds_read_b64_tr_b16 v[144:145], v25 offset:20512
    ds_read_b128 a[124:127], v28 offset:51200
    v_mfma_f32_16x16x32_bf16 v[132:135], a[108:111], v[152:155], v[132:135]
    ds_read_b64_tr_b16 v[146:147], v25 offset:21792
    s_add_u32 s56, s56, s36
    v_mfma_f32_16x16x32_bf16 v[136:139], a[104:107], v[156:159], v[136:139]
    ds_read_b64_tr_b16 v[148:149], v25 offset:25600
    buffer_load_dwordx4 v11, s[8:11], s60 offen offset:3072 lds
    v_mfma_f32_16x16x32_bf16 v[140:143], a[108:111], v[156:159], v[140:143]
    ds_read_b64_tr_b16 v[150:151], v25 offset:26880
    s_add_u32 m0, s63, 102400
    s_waitcnt lgkmcnt(10)
    v_mfma_f32_16x16x32_bf16 v[64:67], v[160:163], a[112:115], v[64:67]
    ds_read_b64_tr_b16 v[152:153], v25 offset:25608
    s_mul_i32 s61, s55, 245760
    s_and_b32 s57, s35, 2
    v_mfma_f32_16x16x32_bf16 v[68:71], v[160:163], a[116:119], v[68:71]
    ds_read_b64_tr_b16 v[154:155], v25 offset:26888
    s_add_u32 s61, s61, s64
    v_mfma_f32_16x16x32_bf16 v[72:75], v[164:167], a[112:115], v[72:75]
    ds_read_b64_tr_b16 v[156:157], v25 offset:25616
    buffer_load_dwordx4 v14, s[12:15], s61 offen offset:0 lds
    s_add_u32 s57, s57, s3
    v_mfma_f32_16x16x32_bf16 v[76:79], v[164:167], a[116:119], v[76:79]
    ds_read_b64_tr_b16 v[158:159], v25 offset:26896
    s_waitcnt lgkmcnt(9)
    v_mfma_f32_16x16x32_bf16 v[80:83], v[168:171], a[112:115], v[80:83]
    ds_read_b64_tr_b16 v[160:161], v25 offset:25624
    v_lshl_add_u32 v7, v4, 5, v1
    v_mfma_f32_16x16x32_bf16 v[84:87], v[168:171], a[116:119], v[84:87]
    ds_read_b64_tr_b16 v[162:163], v25 offset:26904
    v_lshlrev_b32 v7, 3, v7
    v_mfma_f32_16x16x32_bf16 v[88:91], v[172:175], a[112:115], v[88:91]
    ds_read_b64_tr_b16 v[164:165], v25 offset:25632
    buffer_load_dwordx4 v15, s[12:15], s61 offen offset:1024 lds
    v_mfma_f32_16x16x32_bf16 v[92:95], v[172:175], a[116:119], v[92:95]
    ds_read_b64_tr_b16 v[166:167], v25 offset:26912
    s_waitcnt lgkmcnt(8)
    v_mfma_f32_16x16x32_bf16 v[96:99], v[144:147], a[112:115], v[96:99]
    ds_read_b64_tr_b16 v[168:169], v25 offset:30720
    v_add_u32 v7, 4096, v7
    v_mfma_f32_16x16x32_bf16 v[100:103], v[144:147], a[116:119], v[100:103]
    ds_read_b64_tr_b16 v[170:171], v25 offset:32000
    s_and_b32 s58, s57, 3
    v_mfma_f32_16x16x32_bf16 v[104:107], a[112:115], v[148:151], v[104:107]
    ds_read_b64_tr_b16 v[172:173], v25 offset:30728
    s_mulk_i32 s58, 5120
    v_mfma_f32_16x16x32_bf16 v[108:111], a[116:119], v[148:151], v[108:111]
    ds_read_b64_tr_b16 v[174:175], v25 offset:32008
    s_waitcnt lgkmcnt(8)
    v_mfma_f32_16x16x32_bf16 v[112:115], a[112:115], v[152:155], v[112:115]
    ds_read_b64_tr_b16 v[144:145], v25 offset:30736
    buffer_load_dwordx4 v16, s[12:15], s61 offen offset:2048 lds
    v_mfma_f32_16x16x32_bf16 v[116:119], a[116:119], v[152:155], v[116:119]
    ds_read_b64_tr_b16 v[146:147], v25 offset:32016
    v_readfirstlane_b32 s66, v58
    s_nop 0
    s_cmp_eq_u32 s66, 0
    s_cbranch_scc1 L_nonce_spin
L_nonce_ok:
    v_mfma_f32_16x16x32_bf16 v[120:123], a[112:115], v[156:159], v[120:123]
    ds_read_b64_tr_b16 v[148:149], v25 offset:30744
    s_add_u32 s58, s58, s56
    v_mfma_f32_16x16x32_bf16 v[124:127], a[116:119], v[156:159], v[124:127]
    ds_read_b64_tr_b16 v[150:151], v25 offset:32024
    v_add_u32 v54, s58, v9
    s_waitcnt lgkmcnt(8)
    v_mfma_f32_16x16x32_bf16 v[128:131], a[112:115], v[160:163], v[128:131]
    ds_read_b64_tr_b16 v[152:153], v25 offset:30752
    v_add_u32 v0, s58, v7
    v_mfma_f32_16x16x32_bf16 v[132:135], a[116:119], v[160:163], v[132:135]
    ds_read_b64_tr_b16 v[154:155], v25 offset:32032
    buffer_load_dwordx4 v17, s[12:15], s61 offen offset:3072 lds
    v_mfma_f32_16x16x32_bf16 v[136:139], a[112:115], v[164:167], v[136:139]
    ds_read_b64_tr_b16 v[156:157], v25 offset:35840
    s_add_u32 m0, s63, 106496
    v_mfma_f32_16x16x32_bf16 v[140:143], a[116:119], v[164:167], v[140:143]
    ds_read_b64_tr_b16 v[158:159], v25 offset:37120
    s_waitcnt lgkmcnt(8)
    v_mfma_f32_16x16x32_bf16 v[64:67], v[168:171], a[120:123], v[64:67]
    ds_read_b64_tr_b16 v[160:161], v25 offset:35848
    s_add_u32 s58, s57, 1
    v_mfma_f32_16x16x32_bf16 v[68:71], v[168:171], a[124:127], v[68:71]
    ds_read_b64_tr_b16 v[162:163], v25 offset:37128
    s_and_b32 s58, s58, 3
    v_mfma_f32_16x16x32_bf16 v[72:75], v[172:175], a[120:123], v[72:75]
    ds_read_b64_tr_b16 v[164:165], v25 offset:35856
    buffer_load_dwordx4 v18, s[12:15], s61 offen lds
    v_mfma_f32_16x16x32_bf16 v[76:79], v[172:175], a[124:127], v[76:79]
    ds_read_b64_tr_b16 v[166:167], v25 offset:37136
    s_add_u32 m0, s63, 122880
    s_waitcnt lgkmcnt(8)
    v_mfma_f32_16x16x32_bf16 v[80:83], v[144:147], a[120:123], v[80:83]
    ds_read_b64_tr_b16 v[168:169], v25 offset:35864
    s_mulk_i32 s58, 5120
    v_mfma_f32_16x16x32_bf16 v[84:87], v[144:147], a[124:127], v[84:87]
    ds_read_b64_tr_b16 v[170:171], v25 offset:37144
    s_add_u32 s58, s58, s56
    v_mfma_f32_16x16x32_bf16 v[88:91], v[148:151], a[120:123], v[88:91]
    ds_read_b64_tr_b16 v[172:173], v25 offset:35872
    v_add_u32 v55, s58, v9
    v_mfma_f32_16x16x32_bf16 v[92:95], v[148:151], a[124:127], v[92:95]
    ds_read_b64_tr_b16 v[174:175], v25 offset:37152
    s_waitcnt vmcnt(9)
    s_barrier
    s_waitcnt lgkmcnt(8)
    v_mfma_f32_16x16x32_bf16 v[96:99], v[152:155], a[120:123], v[96:99]
    ds_read_b64_tr_b16 v[144:145], v24 offset:20480
    buffer_load_dwordx4 v14, s[12:15], s48 offen offset:0 lds
    ds_read_b128 a[128:131], v27 offset:0
    v_mfma_f32_16x16x32_bf16 v[100:103], v[152:155], a[124:127], v[100:103]
    ds_read_b64_tr_b16 v[146:147], v24 offset:21760
    ds_read_b128 a[132:135], v27 offset:2048
    v_mfma_f32_16x16x32_bf16 v[104:107], a[120:123], v[156:159], v[104:107]
    ds_read_b64_tr_b16 v[148:149], v24 offset:20488
    ds_read_b128 a[136:139], v28 offset:0
    v_mfma_f32_16x16x32_bf16 v[108:111], a[124:127], v[156:159], v[108:111]
    ds_read_b64_tr_b16 v[150:151], v24 offset:21768
    s_waitcnt lgkmcnt(11)
    v_mfma_f32_16x16x32_bf16 v[112:115], a[120:123], v[160:163], v[112:115]
    ds_read_b64_tr_b16 v[152:153], v24 offset:20496
    ds_read_b128 a[140:143], v28 offset:2048
    v_mfma_f32_16x16x32_bf16 v[116:119], a[124:127], v[160:163], v[116:119]
    ds_read_b64_tr_b16 v[154:155], v24 offset:21776
    v_add_u32 v59, s58, v7
    v_mfma_f32_16x16x32_bf16 v[120:123], a[120:123], v[164:167], v[120:123]
    ds_read_b64_tr_b16 v[156:157], v24 offset:20504
    v_add_u32 v8, s57, v4
    v_mfma_f32_16x16x32_bf16 v[124:127], a[124:127], v[164:167], v[124:127]
    ds_read_b64_tr_b16 v[158:159], v24 offset:21784
    s_waitcnt lgkmcnt(12)
    v_mfma_f32_16x16x32_bf16 v[128:131], a[120:123], v[168:171], v[128:131]
    ds_read_b64_tr_b16 v[160:161], v24 offset:20512
    buffer_load_dwordx4 v15, s[12:15], s48 offen offset:1024 lds
    v_mfma_f32_16x16x32_bf16 v[132:135], a[124:127], v[168:171], v[132:135]
    ds_read_b64_tr_b16 v[162:163], v24 offset:21792
    v_and_b32 v8, 3, v8
    v_mfma_f32_16x16x32_bf16 v[136:139], a[120:123], v[172:175], v[136:139]
    ds_read_b64_tr_b16 v[164:165], v24 offset:25600
    v_lshl_add_u32 v8, v8, 1, v5
    v_mfma_f32_16x16x32_bf16 v[140:143], a[124:127], v[172:175], v[140:143]
    ds_read_b64_tr_b16 v[166:167], v24 offset:26880
    s_waitcnt lgkmcnt(9)
    v_mfma_f32_16x16x32_bf16 v[64:67], v[144:147], a[128:131], v[64:67]
    ds_read_b64_tr_b16 v[168:169], v24 offset:25608
    v_mul_u32_u24 v8, 2560, v8
    v_mfma_f32_16x16x32_bf16 v[68:71], v[144:147], a[132:135], v[68:71]
    ds_read_b64_tr_b16 v[170:171], v24 offset:26888
    s_mul_i32 s56, s59, 20480
    v_mfma_f32_16x16x32_bf16 v[72:75], v[148:151], a[128:131], v[72:75]
    ds_read_b64_tr_b16 v[172:173], v24 offset:25616
    s_add_u32 s56, s56, 25165824
    v_mfma_f32_16x16x32_bf16 v[76:79], v[148:151], a[132:135], v[76:79]
    ds_read_b64_tr_b16 v[174:175], v24 offset:26896
    s_waitcnt lgkmcnt(8)
    v_mfma_f32_16x16x32_bf16 v[80:83], v[152:155], a[128:131], v[80:83]
    ds_read_b64_tr_b16 v[144:145], v24 offset:25624
    buffer_load_dwordx4 v16, s[12:15], s48 offen offset:2048 lds
    v_mfma_f32_16x16x32_bf16 v[84:87], v[152:155], a[132:135], v[84:87]
    ds_read_b64_tr_b16 v[146:147], v24 offset:26904
    v_mad_u32_u24 v8, v6, s68, v8
    v_mfma_f32_16x16x32_bf16 v[88:91], v[156:159], a[128:131], v[88:91]
    ds_read_b64_tr_b16 v[148:149], v24 offset:25632
    v_add_u32 v61, s56, v8
    v_mfma_f32_16x16x32_bf16 v[92:95], v[156:159], a[132:135], v[92:95]
    ds_read_b64_tr_b16 v[150:151], v24 offset:26912
    s_waitcnt lgkmcnt(8)
    v_mfma_f32_16x16x32_bf16 v[96:99], v[160:163], a[128:131], v[96:99]
    ds_read_b64_tr_b16 v[152:153], v24 offset:30720
    s_lshr_b32 s56, s35, 1
    v_mfma_f32_16x16x32_bf16 v[100:103], v[160:163], a[132:135], v[100:103]
    ds_read_b64_tr_b16 v[154:155], v24 offset:32000
    s_mul_i32 s57, s56, 51200
    v_mfma_f32_16x16x32_bf16 v[104:107], a[128:131], v[164:167], v[104:107]
    ds_read_b64_tr_b16 v[156:157], v24 offset:30728
    s_sub_u32 s57, s57, 61440
    v_mfma_f32_16x16x32_bf16 v[108:111], a[132:135], v[164:167], v[108:111]
    ds_read_b64_tr_b16 v[158:159], v24 offset:32008
    s_waitcnt lgkmcnt(8)
    v_mfma_f32_16x16x32_bf16 v[112:115], a[128:131], v[168:171], v[112:115]
    ds_read_b64_tr_b16 v[160:161], v24 offset:30736
    buffer_load_dwordx4 v17, s[12:15], s48 offen offset:3072 lds
    v_mfma_f32_16x16x32_bf16 v[116:119], a[132:135], v[168:171], v[116:119]
    ds_read_b64_tr_b16 v[162:163], v24 offset:32016
    s_add_u32 m0, s63, 126976
    v_mfma_f32_16x16x32_bf16 v[120:123], a[128:131], v[172:175], v[120:123]
    ds_read_b64_tr_b16 v[164:165], v24 offset:30744
    v_mad_u32_u24 v8, v4, s68, v24
    v_mfma_f32_16x16x32_bf16 v[124:127], a[132:135], v[172:175], v[124:127]
    ds_read_b64_tr_b16 v[166:167], v24 offset:32024
    s_waitcnt lgkmcnt(8)
    v_mfma_f32_16x16x32_bf16 v[128:131], a[128:131], v[144:147], v[128:131]
    ds_read_b64_tr_b16 v[168:169], v24 offset:30752
    v_add_u32 v48, s57, v8
    v_mfma_f32_16x16x32_bf16 v[132:135], a[132:135], v[144:147], v[132:135]
    ds_read_b64_tr_b16 v[170:171], v24 offset:32032
    v_mul_u32_u24 v8, 15, v4
    v_mfma_f32_16x16x32_bf16 v[136:139], a[128:131], v[148:151], v[136:139]
    ds_read_b64_tr_b16 v[172:173], v24 offset:35840
    v_lshl_add_u32 v8, v5, 2, v8
    v_mfma_f32_16x16x32_bf16 v[140:143], a[132:135], v[148:151], v[140:143]
    ds_read_b64_tr_b16 v[174:175], v24 offset:37120
    s_waitcnt lgkmcnt(8)
    v_mfma_f32_16x16x32_bf16 v[64:67], v[152:155], a[136:139], v[64:67]
    ds_read_b64_tr_b16 v[144:145], v24 offset:35848
    buffer_load_dwordx4 v18, s[12:15], s48 offen lds
    v_mfma_f32_16x16x32_bf16 v[68:71], v[152:155], a[140:143], v[68:71]
    ds_read_b64_tr_b16 v[146:147], v24 offset:37128
    s_add_u32 m0, s63, 61440
    v_mfma_f32_16x16x32_bf16 v[72:75], v[156:159], a[136:139], v[72:75]
    ds_read_b64_tr_b16 v[148:149], v24 offset:35856
    v_mad_u32_u24 v49, v8, s68, v48
    v_mfma_f32_16x16x32_bf16 v[76:79], v[156:159], a[140:143], v[76:79]
    ds_read_b64_tr_b16 v[150:151], v24 offset:37136
    s_waitcnt lgkmcnt(8)
    v_mfma_f32_16x16x32_bf16 v[80:83], v[160:163], a[136:139], v[80:83]
    ds_read_b64_tr_b16 v[152:153], v24 offset:35864
    s_lshl2_add_u32 s56, s56, s37
    v_mfma_f32_16x16x32_bf16 v[84:87], v[160:163], a[140:143], v[84:87]
    ds_read_b64_tr_b16 v[154:155], v24 offset:37144
    s_mulk_i32 s56, 2816
    v_mfma_f32_16x16x32_bf16 v[88:91], v[164:167], a[136:139], v[88:91]
    ds_read_b64_tr_b16 v[156:157], v24 offset:35872
    s_add_u32 s56, s56, 102400
    v_mfma_f32_16x16x32_bf16 v[92:95], v[164:167], a[140:143], v[92:95]
    ds_read_b64_tr_b16 v[158:159], v24 offset:37152
    s_waitcnt vmcnt(5)
    s_barrier
    s_waitcnt lgkmcnt(8)
    v_mfma_f32_16x16x32_bf16 v[96:99], v[168:171], a[136:139], v[96:99]
    ds_read_b64_tr_b16 v[160:161], v24 offset:40960
    buffer_load_dwordx4 v14, s[12:15], s49 offen offset:0 lds
    v_mfma_f32_16x16x32_bf16 v[100:103], v[168:171], a[140:143], v[100:103]
    ds_read_b64_tr_b16 v[162:163], v24 offset:42240
    ds_read_b128 a[144:147], v27 offset:16384
    v_mfma_f32_16x16x32_bf16 v[104:107], a[136:139], v[172:175], v[104:107]
    ds_read_b64_tr_b16 v[164:165], v24 offset:40968
    ds_read_b128 a[148:151], v27 offset:18432
    v_mfma_f32_16x16x32_bf16 v[108:111], a[140:143], v[172:175], v[108:111]
    ds_read_b64_tr_b16 v[166:167], v24 offset:42248
    s_waitcnt lgkmcnt(10)
    v_mfma_f32_16x16x32_bf16 v[112:115], a[136:139], v[144:147], v[112:115]
    ds_read_b64_tr_b16 v[168:169], v24 offset:40976
    ds_read_b128 a[152:155], v28 offset:16384
    v_mfma_f32_16x16x32_bf16 v[116:119], a[140:143], v[144:147], v[116:119]
    ds_read_b64_tr_b16 v[170:171], v24 offset:42256
    ds_read_b128 a[156:159], v28 offset:18432
    v_mfma_f32_16x16x32_bf16 v[120:123], a[136:139], v[148:151], v[120:123]
    ds_read_b64_tr_b16 v[172:173], v24 offset:40984
    v_mul_u32_u24 v8, 176, v3
    v_mfma_f32_16x16x32_bf16 v[124:127], a[140:143], v[148:151], v[124:127]
    ds_read_b64_tr_b16 v[174:175], v24 offset:42264
    s_waitcnt lgkmcnt(12)
    v_mfma_f32_16x16x32_bf16 v[128:131], a[136:139], v[152:155], v[128:131]
    ds_read_b64_tr_b16 v[144:145], v24 offset:40992
    buffer_load_dwordx4 v15, s[12:15], s49 offen offset:1024 lds
    v_mfma_f32_16x16x32_bf16 v[132:135], a[140:143], v[152:155], v[132:135]
    ds_read_b64_tr_b16 v[146:147], v24 offset:42272
    v_mul_u32_u24 v7, 80, v4
    v_mfma_f32_16x16x32_bf16 v[136:139], a[136:139], v[156:159], v[136:139]
    ds_read_b64_tr_b16 v[148:149], v24 offset:46080
    v_add3_u32 v8, v8, v7, s56
    v_mfma_f32_16x16x32_bf16 v[140:143], a[140:143], v[156:159], v[140:143]
    ds_read_b64_tr_b16 v[150:151], v24 offset:47360
    s_waitcnt lgkmcnt(10)
    v_mfma_f32_16x16x32_bf16 v[64:67], v[160:163], a[144:147], v[64:67]
    ds_read_b64_tr_b16 v[152:153], v24 offset:46088
    s_movk_i32 s56, 5664
    v_mfma_f32_16x16x32_bf16 v[68:71], v[160:163], a[148:151], v[68:71]
    ds_read_b64_tr_b16 v[154:155], v24 offset:47368
    v_mad_u32_u24 v50, v5, s56, v8
    v_mfma_f32_16x16x32_bf16 v[72:75], v[164:167], a[144:147], v[72:75]
    ds_read_b64_tr_b16 v[156:157], v24 offset:46096
    s_movk_i32 s56, -5584
    v_mfma_f32_16x16x32_bf16 v[76:79], v[164:167], a[148:151], v[76:79]
    ds_read_b64_tr_b16 v[158:159], v24 offset:47376
    s_waitcnt lgkmcnt(8)
    v_mfma_f32_16x16x32_bf16 v[80:83], v[168:171], a[144:147], v[80:83]
    ds_read_b64_tr_b16 v[160:161], v24 offset:46104
    buffer_load_dwordx4 v16, s[12:15], s49 offen offset:2048 lds
    v_mfma_f32_16x16x32_bf16 v[84:87], v[168:171], a[148:151], v[84:87]
    ds_read_b64_tr_b16 v[162:163], v24 offset:47384
    v_mad_i32_i24 v8, v5, s56, v8
    v_mfma_f32_16x16x32_bf16 v[88:91], v[172:175], a[144:147], v[88:91]
    ds_read_b64_tr_b16 v[164:165], v24 offset:46112
    v_add_u32 v51, 5632, v8
    v_mfma_f32_16x16x32_bf16 v[92:95], v[172:175], a[148:151], v[92:95]
    ds_read_b64_tr_b16 v[166:167], v24 offset:47392
    s_waitcnt lgkmcnt(8)
    v_mfma_f32_16x16x32_bf16 v[96:99], v[144:147], a[144:147], v[96:99]
    ds_read_b64_tr_b16 v[168:169], v24 offset:51200
    v_mul_u32_u24 v7, 205, v1
    v_mfma_f32_16x16x32_bf16 v[100:103], v[144:147], a[148:151], v[100:103]
    ds_read_b64_tr_b16 v[170:171], v24 offset:52480
    v_lshrrev_b32 v7, 11, v7
    v_mfma_f32_16x16x32_bf16 v[104:107], a[144:147], v[148:151], v[104:107]
    ds_read_b64_tr_b16 v[172:173], v24 offset:51208
    s_mul_i32 s56, s35, 1408
    v_mfma_f32_16x16x32_bf16 v[108:111], a[148:151], v[148:151], v[108:111]
    ds_read_b64_tr_b16 v[174:175], v24 offset:52488
    s_waitcnt lgkmcnt(8)
    v_mfma_f32_16x16x32_bf16 v[112:115], a[144:147], v[152:155], v[112:115]
    ds_read_b64_tr_b16 v[144:145], v24 offset:51216
    buffer_load_dwordx4 v17, s[12:15], s49 offen offset:3072 lds
    v_mfma_f32_16x16x32_bf16 v[116:119], a[148:151], v[152:155], v[116:119]
    ds_read_b64_tr_b16 v[146:147], v24 offset:52496
    s_add_u32 m0, s63, 65536
    v_mfma_f32_16x16x32_bf16 v[120:123], a[144:147], v[156:159], v[120:123]
    ds_read_b64_tr_b16 v[148:149], v24 offset:51224
    s_add_u32 s56, s56, 102400
    v_mfma_f32_16x16x32_bf16 v[124:127], a[148:151], v[156:159], v[124:127]
    ds_read_b64_tr_b16 v[150:151], v24 offset:52504
    s_waitcnt lgkmcnt(8)
    v_mfma_f32_16x16x32_bf16 v[128:131], a[144:147], v[160:163], v[128:131]
    ds_read_b64_tr_b16 v[152:153], v24 offset:51232
    v_lshl_add_u32 v8, v7, 4, v9
    v_mfma_f32_16x16x32_bf16 v[132:135], a[148:151], v[160:163], v[132:135]
    ds_read_b64_tr_b16 v[154:155], v24 offset:52512
    v_min_u32 v8, 672, v8
    v_mfma_f32_16x16x32_bf16 v[136:139], a[144:147], v[164:167], v[136:139]
    ds_read_b64_tr_b16 v[156:157], v24 offset:56320
    v_add_u32 v52, s56, v8
    v_mfma_f32_16x16x32_bf16 v[140:143], a[148:151], v[164:167], v[140:143]
    ds_read_b64_tr_b16 v[158:159], v24 offset:57600
    s_waitcnt lgkmcnt(8)
    v_mfma_f32_16x16x32_bf16 v[64:67], v[168:171], a[152:155], v[64:67]
    ds_read_b64_tr_b16 v[160:161], v24 offset:56328
    buffer_load_dwordx4 v18, s[12:15], s49 offen lds
    v_mfma_f32_16x16x32_bf16 v[68:71], v[168:171], a[156:159], v[68:71]
    ds_read_b64_tr_b16 v[162:163], v24 offset:57608
    s_add_u32 m0, s63, 143360
    v_mfma_f32_16x16x32_bf16 v[72:75], v[172:175], a[152:155], v[72:75]
    ds_read_b64_tr_b16 v[164:165], v24 offset:56336
    s_lshl4_add_u32 s58, s33, s35
    v_mfma_f32_16x16x32_bf16 v[76:79], v[172:175], a[156:159], v[76:79]
    ds_read_b64_tr_b16 v[166:167], v24 offset:57616
    s_waitcnt lgkmcnt(8)
    v_mfma_f32_16x16x32_bf16 v[80:83], v[144:147], a[152:155], v[80:83]
    ds_read_b64_tr_b16 v[168:169], v24 offset:56344
    s_lshl4_add_u32 s58, s58, s32
    v_mfma_f32_16x16x32_bf16 v[84:87], v[144:147], a[156:159], v[84:87]
    ds_read_b64_tr_b16 v[170:171], v24 offset:57624
    s_mulk_i32 s58, 1280
    v_mfma_f32_16x16x32_bf16 v[88:91], v[148:151], a[152:155], v[88:91]
    ds_read_b64_tr_b16 v[172:173], v24 offset:56352
    s_add_u32 s58, s58, s47
    v_mfma_f32_16x16x32_bf16 v[92:95], v[148:151], a[156:159], v[92:95]
    ds_read_b64_tr_b16 v[174:175], v24 offset:57632
    s_waitcnt vmcnt(5)
    s_barrier
    s_waitcnt lgkmcnt(8)
    v_mfma_f32_16x16x32_bf16 v[96:99], v[152:155], a[152:155], v[96:99]
    ds_read_b64_tr_b16 v[144:145], v25 offset:0
    buffer_load_dwordx4 v14, s[12:15], s50 offen offset:0 lds
    v_mfma_f32_16x16x32_bf16 v[100:103], v[152:155], a[156:159], v[100:103]
    ds_read_b64_tr_b16 v[146:147], v25 offset:1280
    v_and_b32 v8, 4, v7
    v_mfma_f32_16x16x32_bf16 v[104:107], a[152:155], v[156:159], v[104:107]
    ds_read_b64_tr_b16 v[148:149], v25 offset:8
    v_lshl_add_u32 v8, v8, 24, v9
    v_mfma_f32_16x16x32_bf16 v[108:111], a[156:159], v[156:159], v[108:111]
    ds_read_b64_tr_b16 v[150:151], v25 offset:1288
    s_waitcnt lgkmcnt(8)
    v_mfma_f32_16x16x32_bf16 v[112:115], a[152:155], v[160:163], v[112:115]
    ds_read_b64_tr_b16 v[152:153], v25 offset:16
    v_mul_u32_u24 v7, 2400, v7
    v_mfma_f32_16x16x32_bf16 v[116:119], a[156:159], v[160:163], v[116:119]
    ds_read_b64_tr_b16 v[154:155], v25 offset:1296
    v_add3_u32 v56, v8, v7, s58
    v_mfma_f32_16x16x32_bf16 v[120:123], a[152:155], v[164:167], v[120:123]
    ds_read_b64_tr_b16 v[156:157], v25 offset:24
    buffer_load_dwordx4 v15, s[12:15], s50 offen offset:1024 lds
    v_mfma_f32_16x16x32_bf16 v[124:127], a[156:159], v[164:167], v[124:127]
    ds_read_b64_tr_b16 v[158:159], v25 offset:1304
    s_waitcnt lgkmcnt(8)
    v_mfma_f32_16x16x32_bf16 v[128:131], a[152:155], v[168:171], v[128:131]
    ds_read_b64_tr_b16 v[160:161], v25 offset:32
    v_mfma_f32_16x16x32_bf16 v[132:135], a[156:159], v[168:171], v[132:135]
    ds_read_b64_tr_b16 v[162:163], v25 offset:1312
    v_mfma_f32_16x16x32_bf16 v[136:139], a[152:155], v[172:175], v[136:139]
    ds_read_b64_tr_b16 v[164:165], v25 offset:5120
    v_mfma_f32_16x16x32_bf16 v[140:143], a[156:159], v[172:175], v[140:143]
    ds_read_b64_tr_b16 v[166:167], v25 offset:6400
    s_waitcnt lgkmcnt(8)
    v_mfma_f32_16x16x32_bf16 v[176:179], v[144:147], a[0:3], 0
    ds_read_b64_tr_b16 v[168:169], v25 offset:5128
    buffer_load_dwordx4 v16, s[12:15], s50 offen offset:2048 lds
    v_mfma_f32_16x16x32_bf16 v[180:183], v[144:147], a[4:7], 0
    ds_read_b64_tr_b16 v[170:171], v25 offset:6408
    v_mfma_f32_16x16x32_bf16 v[184:187], v[148:151], a[0:3], 0
    ds_read_b64_tr_b16 v[172:173], v25 offset:5136
    v_mfma_f32_16x16x32_bf16 v[188:191], v[148:151], a[4:7], 0
    ds_read_b64_tr_b16 v[174:175], v25 offset:6416
    s_waitcnt lgkmcnt(8)
    v_mfma_f32_16x16x32_bf16 v[192:195], v[152:155], a[0:3], 0
    ds_read_b64_tr_b16 v[144:145], v25 offset:5144
    v_cvt_pk_bf16_f32 v64, v64, v65
    v_mfma_f32_16x16x32_bf16 v[196:199], v[152:155], a[4:7], 0
    ds_read_b64_tr_b16 v[146:147], v25 offset:6424
    v_cvt_pk_bf16_f32 v65, v66, v67
    v_mfma_f32_16x16x32_bf16 v[200:203], v[156:159], a[0:3], 0
    ds_read_b64_tr_b16 v[148:149], v25 offset:5152
    buffer_load_dwordx4 v17, s[12:15], s50 offen offset:3072 lds
    v_mfma_f32_16x16x32_bf16 v[204:207], v[156:159], a[4:7], 0
    ds_read_b64_tr_b16 v[150:151], v25 offset:6432
    s_waitcnt lgkmcnt(8)
    v_mfma_f32_16x16x32_bf16 v[208:211], v[160:163], a[0:3], 0
    ds_read_b64_tr_b16 v[152:153], v25 offset:10240
    s_add_u32 m0, s63, 147456
    v_mfma_f32_16x16x32_bf16 v[212:215], v[160:163], a[4:7], 0
    ds_read_b64_tr_b16 v[154:155], v25 offset:11520
    v_cvt_pk_bf16_f32 v66, v72, v73
    v_mfma_f32_16x16x32_bf16 v[176:179], v[164:167], a[8:11], v[176:179]
    ds_read_b64_tr_b16 v[156:157], v25 offset:10248
    v_cvt_pk_bf16_f32 v67, v74, v75
    v_mfma_f32_16x16x32_bf16 v[180:183], v[164:167], a[12:15], v[180:183]
    ds_read_b64_tr_b16 v[158:159], v25 offset:11528
    s_waitcnt lgkmcnt(8)
    v_mfma_f32_16x16x32_bf16 v[184:187], v[168:171], a[8:11], v[184:187]
    ds_read_b64_tr_b16 v[160:161], v25 offset:10256
    buffer_load_dwordx4 v18, s[12:15], s50 offen lds
    v_mfma_f32_16x16x32_bf16 v[188:191], v[168:171], a[12:15], v[188:191]
    ds_read_b64_tr_b16 v[162:163], v25 offset:11536
    s_add_u32 m0, s63, 81920
    v_mfma_f32_16x16x32_bf16 v[192:195], v[172:175], a[8:11], v[192:195]
    ds_read_b64_tr_b16 v[164:165], v25 offset:10264
    v_cvt_pk_bf16_f32 v80, v80, v81
    v_mfma_f32_16x16x32_bf16 v[196:199], v[172:175], a[12:15], v[196:199]
    ds_read_b64_tr_b16 v[166:167], v25 offset:11544
    s_waitcnt lgkmcnt(8)
    v_mfma_f32_16x16x32_bf16 v[200:203], v[144:147], a[8:11], v[200:203]
    ds_read_b64_tr_b16 v[168:169], v25 offset:10272
    v_cvt_pk_bf16_f32 v81, v82, v83
    v_mfma_f32_16x16x32_bf16 v[204:207], v[144:147], a[12:15], v[204:207]
    ds_read_b64_tr_b16 v[170:171], v25 offset:11552
    v_cvt_pk_bf16_f32 v82, v88, v89
    v_mfma_f32_16x16x32_bf16 v[208:211], v[148:151], a[8:11], v[208:211]
    ds_read_b64_tr_b16 v[172:173], v25 offset:15360
    v_cvt_pk_bf16_f32 v83, v90, v91
    v_mfma_f32_16x16x32_bf16 v[212:215], v[148:151], a[12:15], v[212:215]
    ds_read_b64_tr_b16 v[174:175], v25 offset:16640
    s_waitcnt lgkmcnt(8)
    v_mfma_f32_16x16x32_bf16 v[176:179], v[152:155], a[16:19], v[176:179]
    ds_read_b64_tr_b16 v[144:145], v25 offset:15368
    buffer_store_dwordx4 v[64:67], v31, s[88:91], s69 offen offset:0 sc1
    v_mfma_f32_16x16x32_bf16 v[180:183], v[152:155], a[20:23], v[180:183]
    ds_read_b64_tr_b16 v[146:147], v25 offset:16648
    v_cvt_pk_bf16_f32 v68, v68, v69
    v_mfma_f32_16x16x32_bf16 v[184:187], v[156:159], a[16:19], v[184:187]
    ds_read_b64_tr_b16 v[148:149], v25 offset:15376
    v_cvt_pk_bf16_f32 v69, v70, v71
    v_mfma_f32_16x16x32_bf16 v[188:191], v[156:159], a[20:23], v[188:191]
    ds_read_b64_tr_b16 v[150:151], v25 offset:16656
    s_waitcnt lgkmcnt(8)
    v_mfma_f32_16x16x32_bf16 v[192:195], v[160:163], a[16:19], v[192:195]
    ds_read_b64_tr_b16 v[152:153], v25 offset:15384
    v_cvt_pk_bf16_f32 v70, v76, v77
    v_mfma_f32_16x16x32_bf16 v[196:199], v[160:163], a[20:23], v[196:199]
    ds_read_b64_tr_b16 v[154:155], v25 offset:16664
    v_cvt_pk_bf16_f32 v71, v78, v79
    v_mfma_f32_16x16x32_bf16 v[200:203], v[164:167], a[16:19], v[200:203]
    ds_read_b64_tr_b16 v[156:157], v25 offset:15392
    buffer_store_dwordx4 v[80:83], v31, s[88:91], s69 offen offset:512 sc1
    v_mfma_f32_16x16x32_bf16 v[204:207], v[164:167], a[20:23], v[204:207]
    ds_read_b64_tr_b16 v[158:159], v25 offset:16672
    s_waitcnt vmcnt(7)
    s_barrier
    s_waitcnt lgkmcnt(8)
    v_mfma_f32_16x16x32_bf16 v[208:211], v[168:171], a[16:19], v[208:211]
    ds_read_b64_tr_b16 v[160:161], v24 offset:0
    buffer_load_dwordx4 v14, s[12:15], s51 offen offset:0 lds
    v_mfma_f32_16x16x32_bf16 v[212:215], v[168:171], a[20:23], v[212:215]
    ds_read_b64_tr_b16 v[162:163], v24 offset:1280
    v_cvt_pk_bf16_f32 v84, v84, v85
    v_mfma_f32_16x16x32_bf16 v[176:179], v[172:175], a[24:27], v[176:179]
    ds_read_b64_tr_b16 v[164:165], v24 offset:8
    v_cvt_pk_bf16_f32 v85, v86, v87
    v_mfma_f32_16x16x32_bf16 v[180:183], v[172:175], a[28:31], v[180:183]
    ds_read_b64_tr_b16 v[166:167], v24 offset:1288
    s_waitcnt lgkmcnt(8)
    v_mfma_f32_16x16x32_bf16 v[184:187], v[144:147], a[24:27], v[184:187]
    ds_read_b64_tr_b16 v[168:169], v24 offset:16
    v_cvt_pk_bf16_f32 v86, v92, v93
    v_mfma_f32_16x16x32_bf16 v[188:191], v[144:147], a[28:31], v[188:191]
    ds_read_b64_tr_b16 v[170:171], v24 offset:1296
    v_cvt_pk_bf16_f32 v87, v94, v95
    v_mfma_f32_16x16x32_bf16 v[192:195], v[148:151], a[24:27], v[192:195]
    ds_read_b64_tr_b16 v[172:173], v24 offset:24
    buffer_load_dwordx4 v15, s[12:15], s51 offen offset:1024 lds
    v_mfma_f32_16x16x32_bf16 v[196:199], v[148:151], a[28:31], v[196:199]
    ds_read_b64_tr_b16 v[174:175], v24 offset:1304
    s_waitcnt lgkmcnt(8)
    v_mfma_f32_16x16x32_bf16 v[200:203], v[152:155], a[24:27], v[200:203]
    ds_read_b64_tr_b16 v[144:145], v24 offset:32
    v_cvt_pk_bf16_f32 v96, v96, v97
    v_mfma_f32_16x16x32_bf16 v[204:207], v[152:155], a[28:31], v[204:207]
    ds_read_b64_tr_b16 v[146:147], v24 offset:1312
    v_cvt_pk_bf16_f32 v97, v98, v99
    v_mfma_f32_16x16x32_bf16 v[208:211], v[156:159], a[24:27], v[208:211]
    ds_read_b64_tr_b16 v[148:149], v24 offset:5120
    v_cvt_pk_bf16_f32 v98, v100, v101
    v_mfma_f32_16x16x32_bf16 v[212:215], v[156:159], a[28:31], v[212:215]
    ds_read_b64_tr_b16 v[150:151], v24 offset:6400
    s_waitcnt lgkmcnt(8)
    v_mfma_f32_16x16x32_bf16 v[176:179], v[160:163], a[32:35], v[176:179]
    ds_read_b64_tr_b16 v[152:153], v24 offset:5128
    buffer_load_dwordx4 v16, s[12:15], s51 offen offset:2048 lds
    v_mfma_f32_16x16x32_bf16 v[180:183], v[160:163], a[36:39], v[180:183]
    ds_read_b64_tr_b16 v[154:155], v24 offset:6408
    v_cvt_pk_bf16_f32 v99, v102, v103
    v_mfma_f32_16x16x32_bf16 v[184:187], v[164:167], a[32:35], v[184:187]
    ds_read_b64_tr_b16 v[156:157], v24 offset:5136
    v_cvt_pk_bf16_f32 v104, v104, v105
    v_mfma_f32_16x16x32_bf16 v[188:191], v[164:167], a[36:39], v[188:191]
    ds_read_b64_tr_b16 v[158:159], v24 offset:6416
    s_waitcnt lgkmcnt(8)
    v_mfma_f32_16x16x32_bf16 v[192:195], v[168:171], a[32:35], v[192:195]
    ds_read_b64_tr_b16 v[160:161], v24 offset:5144
    v_cvt_pk_bf16_f32 v105, v106, v107
    v_mfma_f32_16x16x32_bf16 v[196:199], v[168:171], a[36:39], v[196:199]
    ds_read_b64_tr_b16 v[162:163], v24 offset:6424
    v_cvt_pk_bf16_f32 v106, v108, v109
    v_mfma_f32_16x16x32_bf16 v[200:203], v[172:175], a[32:35], v[200:203]
    ds_read_b64_tr_b16 v[164:165], v24 offset:5152
    buffer_load_dwordx4 v17, s[12:15], s51 offen offset:3072 lds
    v_mfma_f32_16x16x32_bf16 v[204:207], v[172:175], a[36:39], v[204:207]
    ds_read_b64_tr_b16 v[166:167], v24 offset:6432
    s_waitcnt lgkmcnt(8)
    v_mfma_f32_16x16x32_bf16 v[208:211], v[144:147], a[32:35], v[208:211]
    ds_read_b64_tr_b16 v[168:169], v24 offset:10240
    s_add_u32 m0, s63, 86016
    v_mfma_f32_16x16x32_bf16 v[212:215], v[144:147], a[36:39], v[212:215]
    ds_read_b64_tr_b16 v[170:171], v24 offset:11520
    v_cvt_pk_bf16_f32 v107, v110, v111
    v_mfma_f32_16x16x32_bf16 v[176:179], v[148:151], a[40:43], v[176:179]
    ds_read_b64_tr_b16 v[172:173], v24 offset:10248
    v_cvt_pk_bf16_f32 v112, v112, v113
    v_mfma_f32_16x16x32_bf16 v[180:183], v[148:151], a[44:47], v[180:183]
    ds_read_b64_tr_b16 v[174:175], v24 offset:11528
    s_waitcnt lgkmcnt(8)
    v_mfma_f32_16x16x32_bf16 v[184:187], v[152:155], a[40:43], v[184:187]
    ds_read_b64_tr_b16 v[144:145], v24 offset:10256
    buffer_load_dwordx4 v18, s[12:15], s51 offen lds
    v_mfma_f32_16x16x32_bf16 v[188:191], v[152:155], a[44:47], v[188:191]
    ds_read_b64_tr_b16 v[146:147], v24 offset:11536
    s_add_u32 m0, s63, 102400
    v_mfma_f32_16x16x32_bf16 v[192:195], v[156:159], a[40:43], v[192:195]
    ds_read_b64_tr_b16 v[148:149], v24 offset:10264
    v_cvt_pk_bf16_f32 v113, v114, v115
    v_mfma_f32_16x16x32_bf16 v[196:199], v[156:159], a[44:47], v[196:199]
    ds_read_b64_tr_b16 v[150:151], v24 offset:11544
    s_waitcnt lgkmcnt(8)
    v_mfma_f32_16x16x32_bf16 v[200:203], v[160:163], a[40:43], v[200:203]
    ds_read_b64_tr_b16 v[152:153], v24 offset:10272
    v_cvt_pk_bf16_f32 v114, v116, v117
    v_mfma_f32_16x16x32_bf16 v[204:207], v[160:163], a[44:47], v[204:207]
    ds_read_b64_tr_b16 v[154:155], v24 offset:11552
    v_cvt_pk_bf16_f32 v115, v118, v119
    v_mfma_f32_16x16x32_bf16 v[208:211], v[164:167], a[40:43], v[208:211]
    ds_read_b64_tr_b16 v[156:157], v24 offset:15360
    buffer_store_dwordx4 v[68:71], v31, s[88:91], s69 offen offset:128 sc1
    v_mfma_f32_16x16x32_bf16 v[212:215], v[164:167], a[44:47], v[212:215]
    ds_read_b64_tr_b16 v[158:159], v24 offset:16640
    s_waitcnt lgkmcnt(8)
    v_mfma_f32_16x16x32_bf16 v[176:179], v[168:171], a[48:51], v[176:179]
    ds_read_b64_tr_b16 v[160:161], v24 offset:15368
    v_cvt_pk_bf16_f32 v120, v120, v121
    v_mfma_f32_16x16x32_bf16 v[180:183], v[168:171], a[52:55], v[180:183]
    ds_read_b64_tr_b16 v[162:163], v24 offset:16648
    v_cvt_pk_bf16_f32 v121, v122, v123
    v_mfma_f32_16x16x32_bf16 v[184:187], v[172:175], a[48:51], v[184:187]
    ds_read_b64_tr_b16 v[164:165], v24 offset:15376
    v_cvt_pk_bf16_f32 v122, v124, v125
    v_mfma_f32_16x16x32_bf16 v[188:191], v[172:175], a[52:55], v[188:191]
    ds_read_b64_tr_b16 v[166:167], v24 offset:16656
    s_waitcnt lgkmcnt(8)
    v_mfma_f32_16x16x32_bf16 v[192:195], v[144:147], a[48:51], v[192:195]
    ds_read_b64_tr_b16 v[168:169], v24 offset:15384
    v_cvt_pk_bf16_f32 v123, v126, v127
    v_mfma_f32_16x16x32_bf16 v[196:199], v[144:147], a[52:55], v[196:199]
    ds_read_b64_tr_b16 v[170:171], v24 offset:16664
    buffer_store_dwordx4 v[84:87], v31, s[88:91], s69 offen offset:640 sc1
    v_mfma_f32_16x16x32_bf16 v[200:203], v[148:151], a[48:51], v[200:203]
    ds_read_b64_tr_b16 v[172:173], v24 offset:15392
    v_cvt_pk_bf16_f32 v128, v128, v129
    v_mfma_f32_16x16x32_bf16 v[204:207], v[148:151], a[52:55], v[204:207]
    ds_read_b64_tr_b16 v[174:175], v24 offset:16672
    s_waitcnt vmcnt(9)
    s_barrier
    s_waitcnt lgkmcnt(8)
    v_mfma_f32_16x16x32_bf16 v[208:211], v[152:155], a[48:51], v[208:211]
    ds_read_b64_tr_b16 v[144:145], v25 offset:20480
    buffer_load_dwordx4 v14, s[12:15], s52 offen offset:0 lds
    v_mfma_f32_16x16x32_bf16 v[212:215], v[152:155], a[52:55], v[212:215]
    ds_read_b64_tr_b16 v[146:147], v25 offset:21760
    v_cvt_pk_bf16_f32 v129, v130, v131
    v_mfma_f32_16x16x32_bf16 v[176:179], v[156:159], a[56:59], v[176:179]
    ds_read_b64_tr_b16 v[148:149], v25 offset:20488
    v_cvt_pk_bf16_f32 v130, v132, v133
    v_mfma_f32_16x16x32_bf16 v[180:183], v[156:159], a[60:63], v[180:183]
    ds_read_b64_tr_b16 v[150:151], v25 offset:21768
    s_waitcnt lgkmcnt(8)
    v_mfma_f32_16x16x32_bf16 v[184:187], v[160:163], a[56:59], v[184:187]
    ds_read_b64_tr_b16 v[152:153], v25 offset:20496
    v_cvt_pk_bf16_f32 v131, v134, v135
    v_mfma_f32_16x16x32_bf16 v[188:191], v[160:163], a[60:63], v[188:191]
    ds_read_b64_tr_b16 v[154:155], v25 offset:21776
    v_cvt_pk_bf16_f32 v136, v136, v137
    v_mfma_f32_16x16x32_bf16 v[192:195], v[164:167], a[56:59], v[192:195]
    ds_read_b64_tr_b16 v[156:157], v25 offset:20504
    buffer_load_dwordx4 v15, s[12:15], s52 offen offset:1024 lds
    v_mfma_f32_16x16x32_bf16 v[196:199], v[164:167], a[60:63], v[196:199]
    ds_read_b64_tr_b16 v[158:159], v25 offset:21784
    s_waitcnt lgkmcnt(8)
    v_mfma_f32_16x16x32_bf16 v[200:203], v[168:171], a[56:59], v[200:203]
    ds_read_b64_tr_b16 v[160:161], v25 offset:20512
    v_cvt_pk_bf16_f32 v137, v138, v139
    v_mfma_f32_16x16x32_bf16 v[204:207], v[168:171], a[60:63], v[204:207]
    ds_read_b64_tr_b16 v[162:163], v25 offset:21792
    v_cvt_pk_bf16_f32 v138, v140, v141
    v_mfma_f32_16x16x32_bf16 v[208:211], v[172:175], a[56:59], v[208:211]
    ds_read_b64_tr_b16 v[164:165], v25 offset:25600
    v_cvt_pk_bf16_f32 v139, v142, v143
    v_mfma_f32_16x16x32_bf16 v[212:215], v[172:175], a[60:63], v[212:215]
    ds_read_b64_tr_b16 v[166:167], v25 offset:26880
    s_waitcnt lgkmcnt(8)
    v_mfma_f32_16x16x32_bf16 v[176:179], v[144:147], a[64:67], v[176:179]
    ds_read_b64_tr_b16 v[168:169], v25 offset:25608
    buffer_load_dwordx4 v16, s[12:15], s52 offen offset:2048 lds
    v_mfma_f32_16x16x32_bf16 v[180:183], v[144:147], a[68:71], v[180:183]
    ds_read_b64_tr_b16 v[170:171], v25 offset:26888
    ds_write_b128 v31, v[64:67] offset:0
    v_mfma_f32_16x16x32_bf16 v[184:187], v[148:151], a[64:67], v[184:187]
    ds_read_b64_tr_b16 v[172:173], v25 offset:25616
    v_mfma_f32_16x16x32_bf16 v[188:191], v[148:151], a[68:71], v[188:191]
    ds_read_b64_tr_b16 v[174:175], v25 offset:26896
    s_waitcnt lgkmcnt(9)
    v_mfma_f32_16x16x32_bf16 v[192:195], v[152:155], a[64:67], v[192:195]
    ds_read_b64_tr_b16 v[144:145], v25 offset:25624
    v_mfma_f32_16x16x32_bf16 v[196:199], v[152:155], a[68:71], v[196:199]
    ds_read_b64_tr_b16 v[146:147], v25 offset:26904
    v_mfma_f32_16x16x32_bf16 v[200:203], v[156:159], a[64:67], v[200:203]
    ds_read_b64_tr_b16 v[148:149], v25 offset:25632
    buffer_load_dwordx4 v17, s[12:15], s52 offen offset:3072 lds
    v_mfma_f32_16x16x32_bf16 v[204:207], v[156:159], a[68:71], v[204:207]
    ds_read_b64_tr_b16 v[150:151], v25 offset:26912
    s_waitcnt lgkmcnt(9)
    v_mfma_f32_16x16x32_bf16 v[208:211], v[160:163], a[64:67], v[208:211]
    ds_read_b64_tr_b16 v[152:153], v25 offset:30720
    s_add_u32 m0, s63, 106496
    v_mfma_f32_16x16x32_bf16 v[212:215], v[160:163], a[68:71], v[212:215]
    ds_read_b64_tr_b16 v[154:155], v25 offset:32000
    ds_write_b128 v31, v[80:83] offset:512
    v_mfma_f32_16x16x32_bf16 v[176:179], v[164:167], a[72:75], v[176:179]
    ds_read_b64_tr_b16 v[156:157], v25 offset:30728
    buffer_store_dwordx4 v[96:99], v32, s[88:91], s69 offen offset:0 sc1
    v_mfma_f32_16x16x32_bf16 v[180:183], v[164:167], a[76:79], v[180:183]
    ds_read_b64_tr_b16 v[158:159], v25 offset:32008
    s_waitcnt lgkmcnt(9)
    v_mfma_f32_16x16x32_bf16 v[184:187], v[168:171], a[72:75], v[184:187]
    ds_read_b64_tr_b16 v[160:161], v25 offset:30736
    buffer_load_dwordx4 v18, s[12:15], s52 offen lds
    v_mfma_f32_16x16x32_bf16 v[188:191], v[168:171], a[76:79], v[188:191]
    ds_read_b64_tr_b16 v[162:163], v25 offset:32016
    v_mfma_f32_16x16x32_bf16 v[192:195], v[172:175], a[72:75], v[192:195]
    ds_read_b64_tr_b16 v[164:165], v25 offset:30744
    v_mfma_f32_16x16x32_bf16 v[196:199], v[172:175], a[76:79], v[196:199]
    ds_read_b64_tr_b16 v[166:167], v25 offset:32024
    s_waitcnt lgkmcnt(9)
    v_mfma_f32_16x16x32_bf16 v[200:203], v[144:147], a[72:75], v[200:203]
    ds_read_b64_tr_b16 v[168:169], v25 offset:30752
    ds_write_b128 v31, v[68:71] offset:128
    v_mfma_f32_16x16x32_bf16 v[204:207], v[144:147], a[76:79], v[204:207]
    ds_read_b64_tr_b16 v[170:171], v25 offset:32032
    buffer_store_dwordx4 v[104:107], v33, s[88:91], s46 offen offset:0 sc1
    v_mfma_f32_16x16x32_bf16 v[208:211], v[148:151], a[72:75], v[208:211]
    ds_read_b64_tr_b16 v[172:173], v25 offset:35840
    v_mfma_f32_16x16x32_bf16 v[212:215], v[148:151], a[76:79], v[212:215]
    ds_read_b64_tr_b16 v[174:175], v25 offset:37120
    s_waitcnt lgkmcnt(9)
    v_mfma_f32_16x16x32_bf16 v[176:179], v[152:155], a[80:83], v[176:179]
    ds_read_b64_tr_b16 v[144:145], v25 offset:35848
    v_mfma_f32_16x16x32_bf16 v[180:183], v[152:155], a[84:87], v[180:183]
    ds_read_b64_tr_b16 v[146:147], v25 offset:37128
    v_mfma_f32_16x16x32_bf16 v[184:187], v[156:159], a[80:83], v[184:187]
    ds_read_b64_tr_b16 v[148:149], v25 offset:35856
    buffer_store_dwordx4 v[112:115], v33, s[88:91], s46 offen offset:64 sc1
    v_mfma_f32_16x16x32_bf16 v[188:191], v[156:159], a[84:87], v[188:191]
    ds_read_b64_tr_b16 v[150:151], v25 offset:37136
    s_waitcnt lgkmcnt(9)
    v_mfma_f32_16x16x32_bf16 v[192:195], v[160:163], a[80:83], v[192:195]
    ds_read_b64_tr_b16 v[152:153], v25 offset:35864
    ds_write_b128 v31, v[84:87] offset:640
    v_mfma_f32_16x16x32_bf16 v[196:199], v[160:163], a[84:87], v[196:199]
    ds_read_b64_tr_b16 v[154:155], v25 offset:37144
    v_mfma_f32_16x16x32_bf16 v[200:203], v[164:167], a[80:83], v[200:203]
    ds_read_b64_tr_b16 v[156:157], v25 offset:35872
    v_mfma_f32_16x16x32_bf16 v[204:207], v[164:167], a[84:87], v[204:207]
    ds_read_b64_tr_b16 v[158:159], v25 offset:37152
    s_waitcnt vmcnt(10)
    s_barrier
    s_waitcnt lgkmcnt(9)
    v_mfma_f32_16x16x32_bf16 v[208:211], v[168:171], a[80:83], v[208:211]
    ds_read_b64_tr_b16 v[160:161], v24 offset:20480
    buffer_store_dwordx4 v[120:123], v33, s[88:91], s46 offen offset:128 sc1
    v_mfma_f32_16x16x32_bf16 v[212:215], v[168:171], a[84:87], v[212:215]
    ds_read_b64_tr_b16 v[162:163], v24 offset:21760
    v_mfma_f32_16x16x32_bf16 v[176:179], v[172:175], a[88:91], v[176:179]
    ds_read_b64_tr_b16 v[164:165], v24 offset:20488
    v_mfma_f32_16x16x32_bf16 v[180:183], v[172:175], a[92:95], v[180:183]
    ds_read_b64_tr_b16 v[166:167], v24 offset:21768
    s_waitcnt lgkmcnt(9)
    v_mfma_f32_16x16x32_bf16 v[184:187], v[144:147], a[88:91], v[184:187]
    ds_read_b64_tr_b16 v[168:169], v24 offset:20496
    ds_write_b128 v32, v[96:99] offset:0
    v_mfma_f32_16x16x32_bf16 v[188:191], v[144:147], a[92:95], v[188:191]
    ds_read_b64_tr_b16 v[170:171], v24 offset:21776
    v_mfma_f32_16x16x32_bf16 v[192:195], v[148:151], a[88:91], v[192:195]
    ds_read_b64_tr_b16 v[172:173], v24 offset:20504
    buffer_store_dwordx4 v[128:131], v33, s[88:91], s46 offen offset:192 sc1
    v_mfma_f32_16x16x32_bf16 v[196:199], v[148:151], a[92:95], v[196:199]
    ds_read_b64_tr_b16 v[174:175], v24 offset:21784
    s_waitcnt lgkmcnt(9)
    v_mfma_f32_16x16x32_bf16 v[200:203], v[152:155], a[88:91], v[200:203]
    ds_read_b64_tr_b16 v[144:145], v24 offset:20512
    v_mfma_f32_16x16x32_bf16 v[204:207], v[152:155], a[92:95], v[204:207]
    ds_read_b64_tr_b16 v[146:147], v24 offset:21792
    v_mfma_f32_16x16x32_bf16 v[208:211], v[156:159], a[88:91], v[208:211]
    ds_read_b64_tr_b16 v[148:149], v24 offset:25600
    v_mfma_f32_16x16x32_bf16 v[212:215], v[156:159], a[92:95], v[212:215]
    ds_read_b64_tr_b16 v[150:151], v24 offset:26880
    s_waitcnt lgkmcnt(9)
    v_mfma_f32_16x16x32_bf16 v[176:179], v[160:163], a[96:99], v[176:179]
    ds_read_b64_tr_b16 v[152:153], v24 offset:25608
    buffer_store_dwordx4 v[64:67], v31, s[92:95], s69 offen offset:0 sc1
    v_mfma_f32_16x16x32_bf16 v[180:183], v[160:163], a[100:103], v[180:183]
    ds_read_b64_tr_b16 v[154:155], v24 offset:26888
    ds_write_b128 v29, v[104:107] offset:20480
    v_mfma_f32_16x16x32_bf16 v[184:187], v[164:167], a[96:99], v[184:187]
    ds_read_b64_tr_b16 v[156:157], v24 offset:25616
    buffer_store_dwordx4 v[136:139], v33, s[88:91], s46 offen offset:256 sc1
    v_mfma_f32_16x16x32_bf16 v[188:191], v[164:167], a[100:103], v[188:191]
    ds_read_b64_tr_b16 v[158:159], v24 offset:26896
    s_waitcnt lgkmcnt(9)
    v_mfma_f32_16x16x32_bf16 v[192:195], v[168:171], a[96:99], v[192:195]
    ds_read_b64_tr_b16 v[160:161], v24 offset:25624
    v_mfma_f32_16x16x32_bf16 v[196:199], v[168:171], a[100:103], v[196:199]
    ds_read_b64_tr_b16 v[162:163], v24 offset:26904
    v_mfma_f32_16x16x32_bf16 v[200:203], v[172:175], a[96:99], v[200:203]
    ds_read_b64_tr_b16 v[164:165], v24 offset:25632
    buffer_store_dwordx4 v[68:71], v31, s[92:95], s69 offen offset:128 sc1
    v_mfma_f32_16x16x32_bf16 v[204:207], v[172:175], a[100:103], v[204:207]
    ds_read_b64_tr_b16 v[166:167], v24 offset:26912
    s_waitcnt lgkmcnt(9)
    v_mfma_f32_16x16x32_bf16 v[208:211], v[144:147], a[96:99], v[208:211]
    ds_read_b64_tr_b16 v[168:169], v24 offset:30720
    ds_write_b128 v29, v[112:115] offset:20544
    v_mfma_f32_16x16x32_bf16 v[212:215], v[144:147], a[100:103], v[212:215]
    ds_read_b64_tr_b16 v[170:171], v24 offset:32000
    v_mfma_f32_16x16x32_bf16 v[176:179], v[148:151], a[104:107], v[176:179]
    ds_read_b64_tr_b16 v[172:173], v24 offset:30728
    v_mfma_f32_16x16x32_bf16 v[180:183], v[148:151], a[108:111], v[180:183]
    ds_read_b64_tr_b16 v[174:175], v24 offset:32008
    s_waitcnt lgkmcnt(9)
    v_mfma_f32_16x16x32_bf16 v[184:187], v[152:155], a[104:107], v[184:187]
    ds_read_b64_tr_b16 v[144:145], v24 offset:30736
    buffer_store_dwordx4 v[80:83], v31, s[92:95], s69 offen offset:512 sc1
    v_mfma_f32_16x16x32_bf16 v[188:191], v[152:155], a[108:111], v[188:191]
    ds_read_b64_tr_b16 v[146:147], v24 offset:32016
    v_mfma_f32_16x16x32_bf16 v[192:195], v[156:159], a[104:107], v[192:195]
    ds_read_b64_tr_b16 v[148:149], v24 offset:30744
    v_mfma_f32_16x16x32_bf16 v[196:199], v[156:159], a[108:111], v[196:199]
    ds_read_b64_tr_b16 v[150:151], v24 offset:32024
    s_waitcnt lgkmcnt(9)
    v_mfma_f32_16x16x32_bf16 v[200:203], v[160:163], a[104:107], v[200:203]
    ds_read_b64_tr_b16 v[152:153], v24 offset:30752
    ds_write_b128 v29, v[120:123] offset:20608
    v_mfma_f32_16x16x32_bf16 v[204:207], v[160:163], a[108:111], v[204:207]
    ds_read_b64_tr_b16 v[154:155], v24 offset:32032
    v_mfma_f32_16x16x32_bf16 v[208:211], v[164:167], a[104:107], v[208:211]
    ds_read_b64_tr_b16 v[156:157], v24 offset:35840
    buffer_store_dwordx4 v[84:87], v31, s[92:95], s69 offen offset:640 sc1
    v_mfma_f32_16x16x32_bf16 v[212:215], v[164:167], a[108:111], v[212:215]
    ds_read_b64_tr_b16 v[158:159], v24 offset:37120
    s_waitcnt lgkmcnt(9)
    v_mfma_f32_16x16x32_bf16 v[176:179], v[168:171], a[112:115], v[176:179]
    ds_read_b64_tr_b16 v[160:161], v24 offset:35848
    v_accvgpr_write_b32 a4, 0
    v_mfma_f32_16x16x32_bf16 v[180:183], v[168:171], a[116:119], v[180:183]
    ds_read_b64_tr_b16 v[162:163], v24 offset:37128
    v_accvgpr_write_b32 a5, 0
    v_mfma_f32_16x16x32_bf16 v[184:187], v[172:175], a[112:115], v[184:187]
    ds_read_b64_tr_b16 v[164:165], v24 offset:35856
    v_accvgpr_write_b32 a10, 0
    v_mfma_f32_16x16x32_bf16 v[188:191], v[172:175], a[116:119], v[188:191]
    ds_read_b64_tr_b16 v[166:167], v24 offset:37136
    s_waitcnt lgkmcnt(9)
    v_mfma_f32_16x16x32_bf16 v[192:195], v[144:147], a[112:115], v[192:195]
    ds_read_b64_tr_b16 v[168:169], v24 offset:35864
    v_accvgpr_write_b32 a11, 0
    v_mfma_f32_16x16x32_bf16 v[196:199], v[144:147], a[116:119], v[196:199]
    ds_read_b64_tr_b16 v[170:171], v24 offset:37144
    v_accvgpr_write_b32 a16, 0
    v_mfma_f32_16x16x32_bf16 v[200:203], v[148:151], a[112:115], v[200:203]
    ds_read_b64_tr_b16 v[172:173], v24 offset:35872
    v_accvgpr_write_b32 a17, 0
    v_mfma_f32_16x16x32_bf16 v[204:207], v[148:151], a[116:119], v[204:207]
    ds_read_b64_tr_b16 v[174:175], v24 offset:37152
    s_waitcnt vmcnt(9)
    s_barrier
    s_waitcnt lgkmcnt(8)
    v_mfma_f32_16x16x32_bf16 v[208:211], v[152:155], a[112:115], v[208:211]
    ds_read_b64_tr_b16 v[144:145], v24 offset:40960
    v_accvgpr_write_b32 a22, 0
    v_mfma_f32_16x16x32_bf16 v[212:215], v[152:155], a[116:119], v[212:215]
    ds_read_b64_tr_b16 v[146:147], v24 offset:42240
    v_accvgpr_write_b32 a23, 0
    v_mfma_f32_16x16x32_bf16 v[176:179], v[156:159], a[120:123], v[176:179]
    ds_read_b64_tr_b16 v[148:149], v24 offset:46080
    buffer_store_dwordx4 v[96:99], v32, s[92:95], s69 offen offset:0 sc1
    v_mfma_f32_16x16x32_bf16 v[180:183], v[156:159], a[124:127], v[180:183]
    ds_read_b64_tr_b16 v[150:151], v24 offset:47360
    s_waitcnt lgkmcnt(8)
    v_mfma_f32_16x16x32_bf16 v[184:187], v[160:163], a[120:123], v[184:187]
    ds_read_b64_tr_b16 v[152:153], v24 offset:51200
    ds_write_b128 v29, v[128:131] offset:20672
    v_mfma_f32_16x16x32_bf16 v[188:191], v[160:163], a[124:127], v[188:191]
    ds_read_b64_tr_b16 v[154:155], v24 offset:52480
    buffer_store_dwordx4 v[104:107], v33, s[92:95], s46 offen offset:0 sc1
    v_mfma_f32_16x16x32_bf16 v[192:195], v[164:167], a[120:123], v[192:195]
    ds_read_b64_tr_b16 v[156:157], v24 offset:56320
    ds_write_b128 v29, v[136:139] offset:20736
    v_mfma_f32_16x16x32_bf16 v[196:199], v[164:167], a[124:127], v[196:199]
    ds_read_b64_tr_b16 v[158:159], v24 offset:57600
    s_waitcnt lgkmcnt(10)
    v_mfma_f32_16x16x32_bf16 v[200:203], v[168:171], a[120:123], v[200:203]
    ds_read_b64_tr_b16 v[160:161], v24 offset:40968
    buffer_store_dwordx4 v[112:115], v33, s[92:95], s46 offen offset:64 sc1
    v_mfma_f32_16x16x32_bf16 v[204:207], v[168:171], a[124:127], v[204:207]
    ds_read_b64_tr_b16 v[162:163], v24 offset:42248
    v_mfma_f32_16x16x32_bf16 v[208:211], v[172:175], a[120:123], v[208:211]
    ds_read_b64_tr_b16 v[164:165], v24 offset:46088
    v_mfma_f32_16x16x32_bf16 v[212:215], v[172:175], a[124:127], v[212:215]
    ds_read_b64_tr_b16 v[166:167], v24 offset:47368
    s_waitcnt lgkmcnt(10)
    v_mfma_f32_16x16x32_bf16 v[176:179], v[144:147], a[128:131], v[176:179]
    ds_read_b64_tr_b16 v[168:169], v24 offset:51208
    v_mfma_f32_16x16x32_bf16 v[180:183], v[144:147], a[132:135], v[180:183]
    ds_read_b64_tr_b16 v[170:171], v24 offset:52488
    v_mfma_f32_16x16x32_bf16 v[176:179], v[148:151], a[136:139], v[176:179]
    ds_read_b64_tr_b16 v[172:173], v24 offset:56328
    buffer_store_dwordx4 v[120:123], v33, s[92:95], s46 offen offset:128 sc1
    v_mfma_f32_16x16x32_bf16 v[180:183], v[148:151], a[140:143], v[180:183]
    ds_read_b64_tr_b16 v[174:175], v24 offset:57608
    s_waitcnt lgkmcnt(8)
    v_mfma_f32_16x16x32_bf16 v[176:179], v[152:155], a[144:147], v[176:179]
    ds_read_b64_tr_b16 v[144:145], v24 offset:40976
    v_mfma_f32_16x16x32_bf16 v[180:183], v[152:155], a[148:151], v[180:183]
    ds_read_b64_tr_b16 v[146:147], v24 offset:42256
    v_mfma_f32_16x16x32_bf16 v[176:179], v[156:159], a[152:155], v[176:179]
    ds_read_b64_tr_b16 v[148:149], v24 offset:46096
    v_mfma_f32_16x16x32_bf16 v[180:183], v[156:159], a[156:159], v[180:183]
    ds_read_b64_tr_b16 v[150:151], v24 offset:47376
    s_waitcnt lgkmcnt(8)
    v_mfma_f32_16x16x32_bf16 v[184:187], v[160:163], a[128:131], v[184:187]
    ds_read_b64_tr_b16 v[152:153], v24 offset:51216
    buffer_store_dwordx4 v[128:131], v33, s[92:95], s46 offen offset:192 sc1
    v_mfma_f32_16x16x32_bf16 v[188:191], v[160:163], a[132:135], v[188:191]
    ds_read_b64_tr_b16 v[154:155], v24 offset:52496
    v_mfma_f32_16x16x32_bf16 v[184:187], v[164:167], a[136:139], v[184:187]
    ds_read_b64_tr_b16 v[156:157], v24 offset:56336
    v_mfma_f32_16x16x32_bf16 v[188:191], v[164:167], a[140:143], v[188:191]
    ds_read_b64_tr_b16 v[158:159], v24 offset:57616
    s_waitcnt lgkmcnt(8)
    v_mfma_f32_16x16x32_bf16 v[184:187], v[168:171], a[144:147], v[184:187]
    ds_read_b64_tr_b16 v[160:161], v24 offset:40984
    s_waitcnt vmcnt(8)
    v_mfma_f32_16x16x32_bf16 v[188:191], v[168:171], a[148:151], v[188:191]
    ds_read_b64_tr_b16 v[162:163], v24 offset:42264
    buffer_store_dwordx4 v[58:61], v60, s[88:91], 0 offen offset:0 sc1
    v_mfma_f32_16x16x32_bf16 v[184:187], v[172:175], a[152:155], v[184:187]
    ds_read_b64_tr_b16 v[164:165], v24 offset:46104
    v_mul_f32_e64 v176, s40, v176
    v_mfma_f32_16x16x32_bf16 v[188:191], v[172:175], a[156:159], v[188:191]
    ds_read_b64_tr_b16 v[166:167], v24 offset:47384
    s_waitcnt lgkmcnt(8)
    v_mfma_f32_16x16x32_bf16 v[192:195], v[144:147], a[128:131], v[192:195]
    ds_read_b64_tr_b16 v[168:169], v24 offset:51224
    v_mul_f32 v177, s40, v177
    v_mfma_f32_16x16x32_bf16 v[196:199], v[144:147], a[132:135], v[196:199]
    ds_read_b64_tr_b16 v[170:171], v24 offset:52504
    v_mul_f32_e64 v178, s40, v178
    v_mfma_f32_16x16x32_bf16 v[192:195], v[148:151], a[136:139], v[192:195]
    ds_read_b64_tr_b16 v[172:173], v24 offset:56344
    v_mul_f32_e64 v179, s40, v179
    v_mfma_f32_16x16x32_bf16 v[196:199], v[148:151], a[140:143], v[196:199]
    ds_read_b64_tr_b16 v[174:175], v24 offset:57624
    s_waitcnt lgkmcnt(8)
    v_mfma_f32_16x16x32_bf16 v[192:195], v[152:155], a[144:147], v[192:195]
    ds_read_b64_tr_b16 v[144:145], v24 offset:40992
    v_mul_f32 v180, s40, v180
    v_mfma_f32_16x16x32_bf16 v[196:199], v[152:155], a[148:151], v[196:199]
    ds_read_b64_tr_b16 v[146:147], v24 offset:42272
    v_mul_f32_e64 v181, s40, v181
    v_mfma_f32_16x16x32_bf16 v[192:195], v[156:159], a[152:155], v[192:195]
    ds_read_b64_tr_b16 v[148:149], v24 offset:46112
    v_mul_f32_e64 v182, s40, v182
    v_mfma_f32_16x16x32_bf16 v[196:199], v[156:159], a[156:159], v[196:199]
    ds_read_b64_tr_b16 v[150:151], v24 offset:47392
    s_waitcnt lgkmcnt(8)
    v_mfma_f32_16x16x32_bf16 v[200:203], v[160:163], a[128:131], v[200:203]
    ds_read_b64_tr_b16 v[152:153], v24 offset:51232
    v_mul_f32 v183, s40, v183
    v_mfma_f32_16x16x32_bf16 v[204:207], v[160:163], a[132:135], v[204:207]
    ds_read_b64_tr_b16 v[154:155], v24 offset:52512
    buffer_store_dwordx4 v[136:139], v33, s[92:95], s46 offen offset:256 sc1
    v_mfma_f32_16x16x32_bf16 v[200:203], v[164:167], a[136:139], v[200:203]
    ds_read_b64_tr_b16 v[156:157], v24 offset:56352
    v_mul_f32_e64 v184, s40, v184
    v_mfma_f32_16x16x32_bf16 v[204:207], v[164:167], a[140:143], v[204:207]
    ds_read_b64_tr_b16 v[158:159], v24 offset:57632
    s_waitcnt lgkmcnt(8)
    v_mfma_f32_16x16x32_bf16 v[200:203], v[168:171], a[144:147], v[200:203]
    v_mul_f32 v185, s40, v185
    v_mul_f32_e64 v186, s40, v186
    v_mfma_f32_16x16x32_bf16 v[204:207], v[168:171], a[148:151], v[204:207]
    v_mul_f32_e64 v187, s40, v187
    v_cvt_pk_bf16_f32 v176, v176, v177
    v_mfma_f32_16x16x32_bf16 v[200:203], v[172:175], a[152:155], v[200:203]
    v_cvt_pk_bf16_f32 v177, v178, v179
    v_cvt_pk_bf16_f32 v178, v184, v185
    v_mfma_f32_16x16x32_bf16 v[204:207], v[172:175], a[156:159], v[204:207]
    v_cvt_pk_bf16_f32 v179, v186, v187
    s_waitcnt lgkmcnt(4)
    v_mfma_f32_16x16x32_bf16 v[208:211], v[144:147], a[128:131], v[208:211]
    ds_write_b128 v53, v[176:179] offset:0
    v_mul_f32 v188, s40, v188
    v_mfma_f32_16x16x32_bf16 v[212:215], v[144:147], a[132:135], v[212:215]
    v_mul_f32 v189, s40, v189
    v_mul_f32 v190, s40, v190
    v_mfma_f32_16x16x32_bf16 v[208:211], v[148:151], a[136:139], v[208:211]
    v_mul_f32_e64 v191, s40, v191
    v_cvt_pk_bf16_f32 v180, v180, v181
    v_mfma_f32_16x16x32_bf16 v[212:215], v[148:151], a[140:143], v[212:215]
    v_cvt_pk_bf16_f32 v181, v182, v183
    s_waitcnt lgkmcnt(1)
    v_mfma_f32_16x16x32_bf16 v[208:211], v[152:155], a[144:147], v[208:211]
    v_cvt_pk_bf16_f32 v182, v188, v189
    v_cvt_pk_bf16_f32 v183, v190, v191
    v_mfma_f32_16x16x32_bf16 v[212:215], v[152:155], a[148:151], v[212:215]
    ds_write_b128 v53, v[180:183] offset:256
    v_mul_f32 v192, s40, v192
    v_mfma_f32_16x16x32_bf16 v[208:211], v[156:159], a[152:155], v[208:211]
    v_mul_f32 v193, s40, v193
    v_mul_f32 v194, s40, v194
    v_mfma_f32_16x16x32_bf16 v[212:215], v[156:159], a[156:159], v[212:215]
    v_mul_f32 v195, s40, v195
    v_mul_f32 v200, s40, v200
    v_mul_f32 v201, s40, v201
    v_mul_f32 v202, s40, v202
    v_mul_f32_e64 v203, s40, v203
    v_cvt_pk_bf16_f32 v192, v192, v193
    v_cvt_pk_bf16_f32 v193, v194, v195
    v_cvt_pk_bf16_f32 v194, v200, v201
    v_cvt_pk_bf16_f32 v195, v202, v203
    ds_write_b128 v53, v[192:195] offset:512
    v_pk_mul_f32 v[196:197], v[196:197], s[40:41]
    v_pk_mul_f32 v[198:199], v[198:199], s[40:41]
    v_pk_mul_f32 v[204:205], v[204:205], s[40:41]
    v_pk_mul_f32 v[206:207], v[206:207], s[40:41]
    v_cvt_pk_bf16_f32 v196, v196, v197
    v_cvt_pk_bf16_f32 v197, v198, v199
    v_cvt_pk_bf16_f32 v198, v204, v205
    v_cvt_pk_bf16_f32 v199, v206, v207
    ds_write_b128 v53, v[196:199] offset:768
    v_pk_mul_f32 v[208:209], v[208:209], s[40:41]
    v_pk_mul_f32 v[210:211], v[210:211], s[40:41]
    v_pk_mul_f32 v[212:213], v[212:213], s[40:41]
    v_pk_mul_f32 v[214:215], v[214:215], s[40:41]
    v_cvt_pk_bf16_f32 v208, v208, v209
    v_cvt_pk_bf16_f32 v209, v210, v211
    v_cvt_pk_bf16_f32 v210, v212, v213
    v_cvt_pk_bf16_f32 v211, v214, v215
    ds_write_b128 v53, v[208:211] offset:1024
    v_xor_b32 v144, s38, v240
    v_xor_b32 v145, s38, v241
    v_xor_b32 v146, s38, v242
    v_xor_b32 v147, s38, v243
    v_xor_b32 v148, s38, v244
    v_xor_b32 v149, s38, v245
    v_xor_b32 v150, s38, v246
    v_xor_b32 v151, s38, v247
    v_xor_b32 v152, s38, v248
    v_xor_b32 v153, s38, v249
    v_xor_b32 v154, s38, v250
    v_xor_b32 v155, s38, v251
    v_xor_b32 v156, s38, v252
    v_xor_b32 v157, s38, v253
    v_xor_b32 v158, s38, v254
    v_xor_b32 v159, s38, v255
    s_waitcnt lgkmcnt(0)
    s_barrier
    ds_read_b128 a[6:9], v57 offset:1280
    ds_read_b128 v[216:219], v35 offset:0
    ds_read_b64 v[220:221], v36 offset:0
    s_mov_b32 exec_hi, 0
    ds_read_b64 a[10:11], v38 offset:1280
    ds_read_b64 a[16:17], v38 offset:2560
    s_mov_b32 exec_hi, -1
    ds_read_b128 v[222:225], v35 offset:1280
    ds_read_b64 v[226:227], v36 offset:1280
    buffer_load_dword v10, v45, s[24:27], 0 offen offset:1280 sc1
    v_mov_b32 v170, s7
    s_waitcnt lgkmcnt(3)
    v_mfma_f32_32x32x16_bf16 v[176:191], v[216:219], a[6:9], 0
    ds_read_b128 a[12:15], v57 offset:2560
    v_mfma_f32_32x32x8_bf16 v[176:191], v[220:221], a[10:11], v[176:191]
    s_mov_b64 exec, s[44:45]
    ds_read_b128 a[160:163], v30 offset:20480
    ds_read_b128 a[164:167], v30 offset:21120
    ds_read_b128 a[168:171], v30 offset:21760
    ds_read_b128 a[172:175], v30 offset:22400
    s_mov_b64 exec, -1
    s_mov_b32 exec_hi, 0
    ds_read_b64 a[4:5], v38 offset:0
    ds_read_b64 a[22:23], v38 offset:3840
    s_mov_b32 exec_hi, -1
    ds_read_b128 a[0:3], v57 offset:0
    s_waitcnt lgkmcnt(8)
    v_mfma_f32_32x32x16_bf16 v[192:207], v[222:225], a[6:9], v[144:159]
    ds_read_b128 v[228:231], v35 offset:2560
    v_exp_f32 v176, v176
    v_exp_f32 v177, v177
    v_exp_f32 v178, v178
    v_exp_f32_e64 v179, v179
    v_cvt_pk_bf16_f32 v208, v176, v177
    v_cvt_pk_bf16_f32 v209, v178, v179
    v_mfma_f32_32x32x8_bf16 v[192:207], v[226:227], a[10:11], v[192:207]
    s_add_u32 m0, s63, 61440
    v_exp_f32 v180, v180
    v_exp_f32 v181, v181
    v_exp_f32 v182, v182
    v_exp_f32 v183, v183
    v_cvt_pk_bf16_f32 v210, v180, v181
    v_cvt_pk_bf16_f32 v211, v182, v183
    s_waitcnt lgkmcnt(6)
    v_exp_f32 v184, v184
    v_exp_f32 v185, v185
    v_exp_f32 v186, v186
    v_exp_f32_e64 v187, v187
    v_cvt_pk_bf16_f32 v212, v184, v185
    v_cvt_pk_bf16_f32 v213, v186, v187
    v_mfma_f32_32x32x16_bf16 v[80:95], a[160:163], v[208:211], 0
    buffer_load_dwordx4 v19, s[16:19], s101 offen offset:0 lds
    v_exp_f32 v188, v188
    v_exp_f32 v189, v189
    v_exp_f32 v190, v190
    v_exp_f32 v191, v191
    v_cvt_pk_bf16_f32 v214, v188, v189
    v_cvt_pk_bf16_f32 v215, v190, v191
    v_mfma_f32_32x32x16_bf16 v[176:191], v[216:219], a[12:15], 0
    ds_read_b64 v[232:233], v36 offset:2560
    v_exp_f32 v192, v192
    v_exp_f32 v193, v193
    v_exp_f32 v194, v194
    v_exp_f32 v195, v195
    v_cvt_pk_bf16_f32 v208, v192, v193
    v_cvt_pk_bf16_f32 v209, v194, v195
    v_mfma_f32_32x32x8_bf16 v[176:191], v[220:221], a[16:17], v[176:191]
    ds_read_b128 a[18:21], v57 offset:3840
    v_exp_f32 v196, v196
    v_exp_f32 v197, v197
    v_exp_f32 v198, v198
    v_exp_f32 v199, v199
    v_cvt_pk_bf16_f32 v210, v196, v197
    v_cvt_pk_bf16_f32 v211, v198, v199
    v_mfma_f32_32x32x16_bf16 v[80:95], a[164:167], v[212:215], v[80:95]
    s_waitcnt lgkmcnt(6)
    v_exp_f32 v200, v200
    v_exp_f32 v201, v201
    v_exp_f32 v202, v202
    v_exp_f32_e64 v203, v203
    v_cvt_pk_bf16_f32 v212, v200, v201
    v_cvt_pk_bf16_f32 v213, v202, v203
    v_mfma_f32_32x32x16_bf16 v[80:95], a[168:171], v[208:211], v[80:95]
    ds_read_b128 v[234:237], v35 offset:3840
    buffer_load_dwordx4 v20, s[16:19], s101 offen offset:1024 lds
    v_exp_f32 v204, v204
    v_exp_f32 v205, v205
    v_exp_f32 v206, v206
    v_exp_f32 v207, v207
    v_cvt_pk_bf16_f32 v214, v204, v205
    v_cvt_pk_bf16_f32 v215, v206, v207
    v_mfma_f32_32x32x16_bf16 v[192:207], v[222:225], a[12:15], 0
    ds_read_b64 v[238:239], v36 offset:3840
    v_exp_f32 v176, v176
    v_exp_f32 v177, v177
    v_exp_f32 v178, v178
    v_exp_f32 v179, v179
    v_cvt_pk_bf16_f32 v208, v176, v177
    v_cvt_pk_bf16_f32 v209, v178, v179
    v_mfma_f32_32x32x8_bf16 v[192:207], v[226:227], a[16:17], v[192:207]
    s_waitcnt vmcnt(3)
    buffer_store_dwordx4 v[58:61], v60, s[92:95], 0 offen offset:0 sc1
    v_exp_f32 v180, v180
    v_exp_f32 v181, v181
    v_exp_f32 v182, v182
    v_exp_f32_e64 v183, v183
    v_cvt_pk_bf16_f32 v210, v180, v181
    v_cvt_pk_bf16_f32 v211, v182, v183
    v_mfma_f32_32x32x16_bf16 v[80:95], a[172:175], v[212:215], v[80:95]
    s_mov_b64 exec, s[44:45]
    ds_read_b128 a[176:179], v30 offset:23040
    ds_read_b128 a[180:183], v30 offset:23680
    ds_read_b128 a[184:187], v30 offset:24320
    ds_read_b128 a[188:191], v30 offset:24960
    s_mov_b64 exec, -1
    v_exp_f32 v184, v184
    v_exp_f32 v185, v185
    v_exp_f32 v186, v186
    v_exp_f32 v187, v187
    v_cvt_pk_bf16_f32 v212, v184, v185
    v_cvt_pk_bf16_f32 v213, v186, v187
    v_mfma_f32_32x32x16_bf16 v[96:111], a[160:163], v[208:211], 0
    s_waitcnt lgkmcnt(7)
    s_waitcnt vmcnt(3)
    v_cmp_ne_u32 vcc, s66, v10
    s_cbranch_vccnz L_spin_1
L_ok_2:
    buffer_load_dwordx4 a[42:45], v39, s[24:27], 0 offen offset:3840 sc1
    v_exp_f32 v188, v188
    v_exp_f32 v189, v189
    v_exp_f32 v190, v190
    v_exp_f32 v191, v191
    v_cvt_pk_bf16_f32 v214, v188, v189
    v_cvt_pk_bf16_f32 v215, v190, v191
    v_mfma_f32_32x32x16_bf16 v[176:191], v[228:231], a[12:15], v[144:159]
    buffer_load_dwordx2 a[46:47], v40, s[24:27], 0 offen offset:3840 sc1
    v_exp_f32 v192, v192
    v_exp_f32 v193, v193
    v_exp_f32 v194, v194
    v_exp_f32 v195, v195
    v_cvt_pk_bf16_f32 v208, v192, v193
    v_cvt_pk_bf16_f32 v209, v194, v195
    v_mfma_f32_32x32x8_bf16 v[176:191], v[232:233], a[16:17], v[176:191]
    s_mov_b64 exec, s[44:45]
    buffer_load_dwordx4 a[216:219], v41, s[24:27], 0 offen offset:3840 sc1
    buffer_load_dwordx4 a[220:223], v41, s[24:27], s68 offen offset:3840 sc1
    s_mov_b64 exec, -1
    v_exp_f32 v196, v196
    v_exp_f32 v197, v197
    v_exp_f32 v198, v198
    v_exp_f32 v199, v199
    v_cvt_pk_bf16_f32 v210, v196, v197
    v_cvt_pk_bf16_f32 v211, v198, v199
    v_mfma_f32_32x32x16_bf16 v[96:111], a[164:167], v[212:215], v[96:111]
    s_waitcnt lgkmcnt(0)
    v_exp_f32 v200, v200
    v_exp_f32 v201, v201
    v_exp_f32 v202, v202
    v_exp_f32_e64 v203, v203
    v_cvt_pk_bf16_f32 v212, v200, v201
    v_cvt_pk_bf16_f32 v213, v202, v203
    v_mfma_f32_32x32x16_bf16 v[96:111], a[168:171], v[208:211], v[96:111]
    s_barrier
    v_exp_f32 v204, v204
    v_exp_f32 v205, v205
    v_exp_f32 v206, v206
    v_exp_f32_e64 v207, v207
    v_cvt_pk_bf16_f32 v214, v204, v205
    v_cvt_pk_bf16_f32 v215, v206, v207
    v_mfma_f32_32x32x16_bf16 v[192:207], v[216:219], a[18:21], 0
    buffer_load_dwordx4 a[36:39], v39, s[24:27], 0 offen offset:2560 sc1
    v_exp_f32 v176, v176
    v_exp_f32 v177, v177
    v_exp_f32 v178, v178
    v_exp_f32 v179, v179
    v_cvt_pk_bf16_f32 v208, v176, v177
    v_cvt_pk_bf16_f32 v209, v178, v179
    v_mfma_f32_32x32x8_bf16 v[192:207], v[220:221], a[22:23], v[192:207]
    buffer_load_dwordx2 a[40:41], v40, s[24:27], 0 offen offset:2560 sc1
    v_exp_f32 v180, v180
    v_exp_f32 v181, v181
    v_exp_f32 v182, v182
    v_exp_f32 v183, v183
    v_cvt_pk_bf16_f32 v210, v180, v181
    v_cvt_pk_bf16_f32 v211, v182, v183
    v_mfma_f32_32x32x16_bf16 v[96:111], a[172:175], v[212:215], v[96:111]
    v_exp_f32 v184, v184
    v_exp_f32 v185, v185
    v_exp_f32 v186, v186
    v_exp_f32 v187, v187
    v_cvt_pk_bf16_f32 v212, v184, v185
    v_cvt_pk_bf16_f32 v213, v186, v187
    v_mfma_f32_32x32x16_bf16 v[96:111], a[176:179], v[208:211], v[96:111]
    s_mov_b64 exec, s[44:45]
    buffer_load_dwordx4 a[208:211], v41, s[24:27], 0 offen offset:2560 sc1
    buffer_load_dwordx4 a[212:215], v41, s[24:27], s68 offen offset:2560 sc1
    s_mov_b64 exec, -1
    v_exp_f32 v188, v188
    v_exp_f32 v189, v189
    v_exp_f32 v190, v190
    v_exp_f32 v191, v191
    v_cvt_pk_bf16_f32 v214, v188, v189
    v_cvt_pk_bf16_f32 v215, v190, v191
    v_mfma_f32_32x32x16_bf16 v[176:191], v[222:225], a[18:21], 0
    v_exp_f32 v192, v192
    v_exp_f32 v193, v193
    v_exp_f32 v194, v194
    v_exp_f32 v195, v195
    v_cvt_pk_bf16_f32 v208, v192, v193
    v_cvt_pk_bf16_f32 v209, v194, v195
    v_mfma_f32_32x32x8_bf16 v[176:191], v[226:227], a[22:23], v[176:191]
    buffer_load_dwordx4 a[66:69], v42, s[24:27], 0 offen offset:3840 sc1
    v_exp_f32 v196, v196
    v_exp_f32 v197, v197
    v_exp_f32 v198, v198
    v_exp_f32 v199, v199
    v_cvt_pk_bf16_f32 v210, v196, v197
    v_cvt_pk_bf16_f32 v211, v198, v199
    v_mfma_f32_32x32x16_bf16 v[96:111], a[180:183], v[212:215], v[96:111]
    v_exp_f32 v200, v200
    v_exp_f32 v201, v201
    v_exp_f32 v202, v202
    v_exp_f32 v203, v203
    v_cvt_pk_bf16_f32 v212, v200, v201
    v_cvt_pk_bf16_f32 v213, v202, v203
    v_mfma_f32_32x32x16_bf16 v[112:127], a[160:163], v[208:211], 0
    buffer_load_dwordx2 a[70:71], v43, s[24:27], 0 offen offset:3840 sc1
    v_exp_f32 v204, v204
    v_exp_f32 v205, v205
    v_exp_f32 v206, v206
    v_exp_f32 v207, v207
    v_cvt_pk_bf16_f32 v214, v204, v205
    v_cvt_pk_bf16_f32 v215, v206, v207
    v_mfma_f32_32x32x16_bf16 v[192:207], v[228:231], a[18:21], 0
    buffer_load_dword v11, v45, s[24:27], 0 offen offset:0 sc1
    v_exp_f32 v176, v176
    v_exp_f32 v177, v177
    v_exp_f32 v178, v178
    v_exp_f32 v179, v179
    v_cvt_pk_bf16_f32 v208, v176, v177
    v_cvt_pk_bf16_f32 v209, v178, v179
    v_mfma_f32_32x32x8_bf16 v[192:207], v[232:233], a[22:23], v[192:207]
    v_exp_f32 v180, v180
    v_exp_f32 v181, v181
    v_exp_f32 v182, v182
    v_exp_f32 v183, v183
    v_cvt_pk_bf16_f32 v210, v180, v181
    v_cvt_pk_bf16_f32 v211, v182, v183
    v_mfma_f32_32x32x16_bf16 v[112:127], a[164:167], v[212:215], v[112:127]
    s_mov_b64 exec, s[44:45]
    buffer_load_dwordx4 a[248:251], v44, s[24:27], 0 offen offset:3840 sc1
    buffer_load_dwordx4 a[252:255], v44, s[24:27], s68 offen offset:3840 sc1
    s_mov_b64 exec, -1
    v_exp_f32 v184, v184
    v_exp_f32 v185, v185
    v_exp_f32 v186, v186
    v_exp_f32 v187, v187
    v_cvt_pk_bf16_f32 v212, v184, v185
    v_cvt_pk_bf16_f32 v213, v186, v187
    v_mfma_f32_32x32x16_bf16 v[112:127], a[168:171], v[208:211], v[112:127]
    v_exp_f32 v188, v188
    v_exp_f32 v189, v189
    v_exp_f32 v190, v190
    v_exp_f32 v191, v191
    v_cvt_pk_bf16_f32 v214, v188, v189
    v_cvt_pk_bf16_f32 v215, v190, v191
    v_mfma_f32_32x32x16_bf16 v[176:191], v[234:237], a[18:21], v[144:159]
    buffer_load_dwordx4 a[60:63], v42, s[24:27], 0 offen offset:2560 sc1
    v_exp_f32 v192, v192
    v_exp_f32 v193, v193
    v_exp_f32 v194, v194
    v_exp_f32 v195, v195
    v_cvt_pk_bf16_f32 v208, v192, v193
    v_cvt_pk_bf16_f32 v209, v194, v195
    v_mfma_f32_32x32x8_bf16 v[176:191], v[238:239], a[22:23], v[176:191]
    v_exp_f32 v196, v196
    v_exp_f32 v197, v197
    v_exp_f32 v198, v198
    v_exp_f32 v199, v199
    v_cvt_pk_bf16_f32 v210, v196, v197
    v_cvt_pk_bf16_f32 v211, v198, v199
    v_mfma_f32_32x32x16_bf16 v[112:127], a[172:175], v[212:215], v[112:127]
    buffer_load_dwordx2 a[64:65], v43, s[24:27], 0 offen offset:2560 sc1
    v_exp_f32 v200, v200
    v_exp_f32 v201, v201
    v_exp_f32 v202, v202
    v_exp_f32 v203, v203
    v_cvt_pk_bf16_f32 v212, v200, v201
    v_cvt_pk_bf16_f32 v213, v202, v203
    v_mfma_f32_32x32x16_bf16 v[112:127], a[176:179], v[208:211], v[112:127]
    s_waitcnt vmcnt(13)
    v_exp_f32 v204, v204
    v_exp_f32 v205, v205
    v_exp_f32 v206, v206
    v_exp_f32_e64 v207, v207
    v_cvt_pk_bf16_f32 v214, v204, v205
    v_cvt_pk_bf16_f32 v215, v206, v207
    v_mfma_f32_32x32x16_bf16 v[192:207], a[42:45], a[18:21], 0
    s_mov_b64 exec, s[44:45]
    buffer_load_dwordx4 a[240:243], v44, s[24:27], 0 offen offset:2560 sc1
    buffer_load_dwordx4 a[244:247], v44, s[24:27], s68 offen offset:2560 sc1
    s_mov_b64 exec, -1
    v_exp_f32 v176, v176
    v_exp_f32 v177, v177
    v_exp_f32 v178, v178
    v_exp_f32 v179, v179
    v_cvt_pk_bf16_f32 v208, v176, v177
    v_cvt_pk_bf16_f32 v209, v178, v179
    v_mfma_f32_32x32x8_bf16 v[192:207], a[46:47], a[22:23], v[192:207]
    v_exp_f32 v180, v180
    v_exp_f32 v181, v181
    v_exp_f32 v182, v182
    v_exp_f32 v183, v183
    v_cvt_pk_bf16_f32 v210, v180, v181
    v_cvt_pk_bf16_f32 v211, v182, v183
    v_mfma_f32_32x32x16_bf16 v[112:127], a[180:183], v[212:215], v[112:127]
    v_exp_f32 v184, v184
    v_exp_f32 v185, v185
    v_exp_f32 v186, v186
    v_exp_f32 v187, v187
    v_cvt_pk_bf16_f32 v212, v184, v185
    v_cvt_pk_bf16_f32 v213, v186, v187
    v_mfma_f32_32x32x16_bf16 v[112:127], a[184:187], v[208:211], v[112:127]
    v_exp_f32 v188, v188
    v_exp_f32 v189, v189
    v_exp_f32 v190, v190
    v_exp_f32 v191, v191
    v_cvt_pk_bf16_f32 v214, v188, v189
    v_cvt_pk_bf16_f32 v215, v190, v191
    v_mfma_f32_32x32x16_bf16 v[176:191], a[42:45], a[12:15], 0
    v_exp_f32 v192, v192
    v_exp_f32 v193, v193
    v_exp_f32 v194, v194
    v_exp_f32 v195, v195
    v_cvt_pk_bf16_f32 v208, v192, v193
    v_cvt_pk_bf16_f32 v209, v194, v195
    v_mfma_f32_32x32x8_bf16 v[176:191], a[46:47], a[16:17], v[176:191]
    v_exp_f32 v196, v196
    v_exp_f32 v197, v197
    v_exp_f32 v198, v198
    v_exp_f32 v199, v199
    v_cvt_pk_bf16_f32 v210, v196, v197
    v_cvt_pk_bf16_f32 v211, v198, v199
    v_mfma_f32_32x32x16_bf16 v[112:127], a[188:191], v[212:215], v[112:127]
    s_waitcnt vmcnt(13)
    v_exp_f32 v200, v200
    v_exp_f32 v201, v201
    v_exp_f32 v202, v202
    v_exp_f32_e64 v203, v203
    v_cvt_pk_bf16_f32 v212, v200, v201
    v_cvt_pk_bf16_f32 v213, v202, v203
    v_mfma_f32_32x32x16_bf16 v[112:127], a[216:219], v[208:211], v[112:127]
    s_waitcnt vmcnt(11)
    v_exp_f32 v204, v204
    v_exp_f32 v205, v205
    v_exp_f32 v206, v206
    v_exp_f32_e64 v207, v207
    v_cvt_pk_bf16_f32 v214, v204, v205
    v_cvt_pk_bf16_f32 v215, v206, v207
    v_mfma_f32_32x32x16_bf16 v[192:207], a[36:39], a[18:21], 0
    s_waitcnt vmcnt(6)
    v_cmp_ne_u32 vcc, s66, v11
    v_exp_f32 v176, v176
    v_exp_f32 v177, v177
    v_exp_f32 v178, v178
    v_exp_f32 v179, v179
    v_cvt_pk_bf16_f32 v208, v176, v177
    v_cvt_pk_bf16_f32 v209, v178, v179
    v_mfma_f32_32x32x8_bf16 v[192:207], a[40:41], a[22:23], v[192:207]
    s_cbranch_vccnz L_spin_3
L_ok_4:
    buffer_load_dwordx4 a[30:33], v39, s[24:27], 0 offen offset:1280 sc1
    v_exp_f32 v180, v180
    v_exp_f32 v181, v181
    v_exp_f32 v182, v182
    v_exp_f32_e64 v183, v183
    v_cvt_pk_bf16_f32 v210, v180, v181
    v_cvt_pk_bf16_f32 v211, v182, v183
    v_mfma_f32_32x32x16_bf16 v[112:127], a[220:223], v[212:215], v[112:127]
    buffer_load_dwordx2 a[34:35], v40, s[24:27], 0 offen offset:1280 sc1
    v_exp_f32 v184, v184
    v_exp_f32 v185, v185
    v_exp_f32 v186, v186
    v_exp_f32 v187, v187
    v_cvt_pk_bf16_f32 v212, v184, v185
    v_cvt_pk_bf16_f32 v213, v186, v187
    v_mfma_f32_32x32x16_bf16 v[96:111], a[216:219], v[208:211], v[96:111]
    s_mov_b64 exec, s[44:45]
    buffer_load_dwordx4 a[200:203], v41, s[24:27], 0 offen offset:1280 sc1
    buffer_load_dwordx4 a[204:207], v41, s[24:27], s68 offen offset:1280 sc1
    s_mov_b64 exec, -1
    v_exp_f32 v188, v188
    v_exp_f32 v189, v189
    v_exp_f32 v190, v190
    v_exp_f32 v191, v191
    v_cvt_pk_bf16_f32 v214, v188, v189
    v_cvt_pk_bf16_f32 v215, v190, v191
    v_mfma_f32_32x32x16_bf16 v[176:191], a[36:39], a[12:15], 0
    buffer_load_dwordx4 a[24:27], v39, s[24:27], 0 offen offset:0 sc1
    v_exp_f32 v192, v192
    v_exp_f32 v193, v193
    v_exp_f32 v194, v194
    v_exp_f32 v195, v195
    v_cvt_pk_bf16_f32 v208, v192, v193
    v_cvt_pk_bf16_f32 v209, v194, v195
    v_mfma_f32_32x32x8_bf16 v[176:191], a[40:41], a[16:17], v[176:191]
    buffer_load_dwordx2 a[28:29], v40, s[24:27], 0 offen offset:0 sc1
    v_exp_f32 v196, v196
    v_exp_f32 v197, v197
    v_exp_f32 v198, v198
    v_exp_f32 v199, v199
    v_cvt_pk_bf16_f32 v210, v196, v197
    v_cvt_pk_bf16_f32 v211, v198, v199
    v_mfma_f32_32x32x16_bf16 v[96:111], a[220:223], v[212:215], v[96:111]
    s_mov_b64 exec, s[44:45]
    buffer_load_dwordx4 a[192:195], v41, s[24:27], 0 offen offset:0 sc1
    buffer_load_dwordx4 a[196:199], v41, s[24:27], s68 offen offset:0 sc1
    s_mov_b64 exec, -1
    v_exp_f32 v200, v200
    v_exp_f32 v201, v201
    v_exp_f32 v202, v202
    v_exp_f32 v203, v203
    v_cvt_pk_bf16_f32 v212, v200, v201
    v_cvt_pk_bf16_f32 v213, v202, v203
    v_mfma_f32_32x32x16_bf16 v[112:127], a[208:211], v[208:211], v[112:127]
    buffer_load_dwordx4 a[54:57], v42, s[24:27], 0 offen offset:1280 sc1
    v_exp_f32 v204, v204
    v_exp_f32 v205, v205
    v_exp_f32 v206, v206
    v_exp_f32 v207, v207
    v_cvt_pk_bf16_f32 v214, v204, v205
    v_cvt_pk_bf16_f32 v215, v206, v207
    v_mfma_f32_32x32x16_bf16 v[192:207], a[66:69], a[18:21], v[240:255]
    buffer_load_dwordx2 a[58:59], v43, s[24:27], 0 offen offset:1280 sc1
    v_exp_f32 v176, v176
    v_exp_f32 v177, v177
    v_exp_f32 v178, v178
    v_exp_f32 v179, v179
    v_cvt_pk_bf16_f32 v208, v176, v177
    v_cvt_pk_bf16_f32 v209, v178, v179
    v_mfma_f32_32x32x8_bf16 v[192:207], a[70:71], a[22:23], v[192:207]
    v_exp_f32 v180, v180
    v_exp_f32 v181, v181
    v_exp_f32 v182, v182
    v_exp_f32 v183, v183
    v_cvt_pk_bf16_f32 v210, v180, v181
    v_cvt_pk_bf16_f32 v211, v182, v183
    v_mfma_f32_32x32x16_bf16 v[112:127], a[212:215], v[212:215], v[112:127]
    s_mov_b64 exec, s[44:45]
    buffer_load_dwordx4 a[232:235], v44, s[24:27], 0 offen offset:1280 sc1
    buffer_load_dwordx4 a[236:239], v44, s[24:27], s68 offen offset:1280 sc1
    s_mov_b64 exec, -1
    v_exp_f32 v184, v184
    v_exp_f32 v185, v185
    v_exp_f32 v186, v186
    v_exp_f32 v187, v187
    v_cvt_pk_bf16_f32 v212, v184, v185
    v_cvt_pk_bf16_f32 v213, v186, v187
    v_mfma_f32_32x32x16_bf16 v[96:111], a[208:211], v[208:211], v[96:111]
    buffer_load_dwordx4 a[48:51], v42, s[24:27], 0 offen offset:0 sc1
    v_exp_f32 v188, v188
    v_exp_f32 v189, v189
    v_exp_f32 v190, v190
    v_exp_f32 v191, v191
    v_cvt_pk_bf16_f32 v214, v188, v189
    v_cvt_pk_bf16_f32 v215, v190, v191
    v_mfma_f32_32x32x16_bf16 v[176:191], a[66:69], a[12:15], 0
    v_exp_f32 v192, v192
    v_exp_f32 v193, v193
    v_exp_f32 v194, v194
    v_exp_f32 v195, v195
    v_cvt_pk_bf16_f32 v208, v192, v193
    v_cvt_pk_bf16_f32 v209, v194, v195
    v_mfma_f32_32x32x8_bf16 v[176:191], a[70:71], a[16:17], v[176:191]
    buffer_load_dwordx2 a[52:53], v43, s[24:27], 0 offen offset:0 sc1
    v_exp_f32 v196, v196
    v_exp_f32 v197, v197
    v_exp_f32 v198, v198
    v_exp_f32 v199, v199
    v_cvt_pk_bf16_f32 v210, v196, v197
    v_cvt_pk_bf16_f32 v211, v198, v199
    v_mfma_f32_32x32x16_bf16 v[96:111], a[212:215], v[212:215], v[96:111]
    s_waitcnt vmcnt(18)
    v_exp_f32 v200, v200
    v_exp_f32 v201, v201
    v_exp_f32 v202, v202
    v_exp_f32_e64 v203, v203
    v_cvt_pk_bf16_f32 v212, v200, v201
    v_cvt_pk_bf16_f32 v213, v202, v203
    v_mfma_f32_32x32x16_bf16 v[112:127], a[248:251], v[208:211], v[112:127]
    s_waitcnt vmcnt(16)
    v_exp_f32 v204, v204
    v_exp_f32 v205, v205
    v_exp_f32 v206, v206
    v_exp_f32_e64 v207, v207
    v_cvt_pk_bf16_f32 v214, v204, v205
    v_cvt_pk_bf16_f32 v215, v206, v207
    v_mfma_f32_32x32x16_bf16 v[192:207], a[60:63], a[12:15], v[240:255]
    s_mov_b64 exec, s[44:45]
    buffer_load_dwordx4 a[224:227], v44, s[24:27], 0 offen offset:0 sc1
    buffer_load_dwordx4 a[228:231], v44, s[24:27], s68 offen offset:0 sc1
    s_mov_b64 exec, -1
    v_exp_f32 v176, v176
    v_exp_f32 v177, v177
    v_exp_f32 v178, v178
    v_exp_f32 v179, v179
    v_cvt_pk_bf16_f32 v208, v176, v177
    v_cvt_pk_bf16_f32 v209, v178, v179
    v_mfma_f32_32x32x8_bf16 v[192:207], a[64:65], a[16:17], v[192:207]
    v_exp_f32 v180, v180
    v_exp_f32 v181, v181
    v_exp_f32 v182, v182
    v_exp_f32 v183, v183
    v_cvt_pk_bf16_f32 v210, v180, v181
    v_cvt_pk_bf16_f32 v211, v182, v183
    v_mfma_f32_32x32x16_bf16 v[112:127], a[252:255], v[212:215], v[112:127]
    v_exp_f32 v184, v184
    v_exp_f32 v185, v185
    v_exp_f32 v186, v186
    v_exp_f32 v187, v187
    v_cvt_pk_bf16_f32 v212, v184, v185
    v_cvt_pk_bf16_f32 v213, v186, v187
    v_mfma_f32_32x32x16_bf16 v[96:111], a[248:251], v[208:211], v[96:111]
    s_waitcnt vmcnt(14)
    v_exp_f32 v188, v188
    v_exp_f32 v189, v189
    v_exp_f32 v190, v190
    v_exp_f32_e64 v191, v191
    v_cvt_pk_bf16_f32 v214, v188, v189
    v_cvt_pk_bf16_f32 v215, v190, v191
    v_mfma_f32_32x32x16_bf16 v[176:191], a[30:33], a[18:21], 0
    v_exp_f32 v192, v192
    v_exp_f32 v193, v193
    v_exp_f32 v194, v194
    v_exp_f32 v195, v195
    v_cvt_pk_bf16_f32 v208, v192, v193
    v_cvt_pk_bf16_f32 v209, v194, v195
    v_mfma_f32_32x32x8_bf16 v[176:191], a[34:35], a[22:23], v[176:191]
    v_exp_f32 v196, v196
    v_exp_f32 v197, v197
    v_exp_f32 v198, v198
    v_exp_f32 v199, v199
    v_cvt_pk_bf16_f32 v210, v196, v197
    v_cvt_pk_bf16_f32 v211, v198, v199
    v_mfma_f32_32x32x16_bf16 v[96:111], a[252:255], v[212:215], v[96:111]
    v_exp_f32 v200, v200
    v_exp_f32 v201, v201
    v_exp_f32 v202, v202
    v_exp_f32 v203, v203
    v_cvt_pk_bf16_f32 v212, v200, v201
    v_cvt_pk_bf16_f32 v213, v202, v203
    v_mfma_f32_32x32x16_bf16 v[96:111], a[240:243], v[208:211], v[96:111]
    v_exp_f32 v204, v204
    v_exp_f32 v205, v205
    v_exp_f32 v206, v206
    v_exp_f32 v207, v207
    v_cvt_pk_bf16_f32 v214, v204, v205
    v_cvt_pk_bf16_f32 v215, v206, v207
    v_mfma_f32_32x32x16_bf16 v[192:207], a[30:33], a[12:15], 0
    v_exp_f32 v176, v176
    v_exp_f32 v177, v177
    v_exp_f32 v178, v178
    v_exp_f32 v179, v179
    v_cvt_pk_bf16_f32 v208, v176, v177
    v_cvt_pk_bf16_f32 v209, v178, v179
    v_mfma_f32_32x32x8_bf16 v[192:207], a[34:35], a[16:17], v[192:207]
    v_exp_f32 v180, v180
    v_exp_f32 v181, v181
    v_exp_f32 v182, v182
    v_exp_f32 v183, v183
    v_cvt_pk_bf16_f32 v210, v180, v181
    v_cvt_pk_bf16_f32 v211, v182, v183
    v_mfma_f32_32x32x16_bf16 v[96:111], a[244:247], v[212:215], v[96:111]
    s_waitcnt vmcnt(12)
    v_exp_f32 v184, v184
    v_exp_f32 v185, v185
    v_exp_f32 v186, v186
    v_exp_f32_e64 v187, v187
    v_cvt_pk_bf16_f32 v212, v184, v185
    v_cvt_pk_bf16_f32 v213, v186, v187
    v_mfma_f32_32x32x16_bf16 v[112:127], a[200:203], v[208:211], v[112:127]
    s_waitcnt vmcnt(10)
    v_exp_f32 v188, v188
    v_exp_f32 v189, v189
    v_exp_f32 v190, v190
    v_exp_f32_e64 v191, v191
    v_cvt_pk_bf16_f32 v214, v188, v189
    v_cvt_pk_bf16_f32 v215, v190, v191
    v_mfma_f32_32x32x16_bf16 v[176:191], a[24:27], a[18:21], 0
    buffer_load_dwordx4 v21, s[16:19], s101 offen offset:2048 lds
    v_exp_f32 v192, v192
    v_exp_f32 v193, v193
    v_exp_f32 v194, v194
    v_exp_f32 v195, v195
    v_cvt_pk_bf16_f32 v208, v192, v193
    v_cvt_pk_bf16_f32 v209, v194, v195
    v_mfma_f32_32x32x8_bf16 v[176:191], a[28:29], a[22:23], v[176:191]
    buffer_load_dwordx4 v22, s[16:19], s101 offen offset:3072 lds
    v_exp_f32 v196, v196
    v_exp_f32 v197, v197
    v_exp_f32 v198, v198
    v_exp_f32 v199, v199
    v_cvt_pk_bf16_f32 v210, v196, v197
    v_cvt_pk_bf16_f32 v211, v198, v199
    v_mfma_f32_32x32x16_bf16 v[112:127], a[204:207], v[212:215], v[112:127]
    s_add_u32 m0, s63, 65536
    v_exp_f32 v200, v200
    v_exp_f32 v201, v201
    v_exp_f32 v202, v202
    v_exp_f32 v203, v203
    v_cvt_pk_bf16_f32 v212, v200, v201
    v_cvt_pk_bf16_f32 v213, v202, v203
    v_mfma_f32_32x32x16_bf16 v[96:111], a[200:203], v[208:211], v[96:111]
    buffer_load_dwordx4 v23, s[16:19], s101 offen lds
    v_exp_f32 v204, v204
    v_exp_f32 v205, v205
    v_exp_f32 v206, v206
    v_exp_f32 v207, v207
    v_cvt_pk_bf16_f32 v214, v204, v205
    v_cvt_pk_bf16_f32 v215, v206, v207
    v_mfma_f32_32x32x16_bf16 v[192:207], a[24:27], a[12:15], 0
    s_add_u32 m0, s63, 81920
    v_exp_f32 v176, v176
    v_exp_f32 v177, v177
    v_exp_f32 v178, v178
    v_exp_f32 v179, v179
    v_cvt_pk_bf16_f32 v208, v176, v177
    v_cvt_pk_bf16_f32 v209, v178, v179
    v_mfma_f32_32x32x8_bf16 v[192:207], a[28:29], a[16:17], v[192:207]
    v_exp_f32 v180, v180
    v_exp_f32 v181, v181
    v_exp_f32 v182, v182
    v_exp_f32 v183, v183
    v_cvt_pk_bf16_f32 v210, v180, v181
    v_cvt_pk_bf16_f32 v211, v182, v183
    v_mfma_f32_32x32x16_bf16 v[96:111], a[204:207], v[212:215], v[96:111]
    s_waitcnt vmcnt(11)
    v_exp_f32 v184, v184
    v_exp_f32 v185, v185
    v_exp_f32 v186, v186
    v_exp_f32_e64 v187, v187
    v_cvt_pk_bf16_f32 v212, v184, v185
    v_cvt_pk_bf16_f32 v213, v186, v187
    v_mfma_f32_32x32x16_bf16 v[112:127], a[192:195], v[208:211], v[112:127]
    buffer_load_dwordx4 v19, s[16:19], s67 offen offset:0 lds
    v_exp_f32 v188, v188
    v_exp_f32 v189, v189
    v_exp_f32 v190, v190
    v_exp_f32 v191, v191
    v_cvt_pk_bf16_f32 v214, v188, v189
    v_cvt_pk_bf16_f32 v215, v190, v191
    v_mfma_f32_32x32x16_bf16 v[176:191], a[42:45], a[6:9], 0
    buffer_load_dwordx4 v20, s[16:19], s67 offen offset:1024 lds
    v_exp_f32 v192, v192
    v_exp_f32 v193, v193
    v_exp_f32 v194, v194
    v_exp_f32 v195, v195
    v_cvt_pk_bf16_f32 v208, v192, v193
    v_cvt_pk_bf16_f32 v209, v194, v195
    v_mfma_f32_32x32x8_bf16 v[176:191], a[46:47], a[10:11], v[176:191]
    v_exp_f32 v196, v196
    v_exp_f32 v197, v197
    v_exp_f32 v198, v198
    v_exp_f32 v199, v199
    v_cvt_pk_bf16_f32 v210, v196, v197
    v_cvt_pk_bf16_f32 v211, v198, v199
    v_mfma_f32_32x32x16_bf16 v[112:127], a[196:199], v[212:215], v[112:127]
    v_exp_f32 v200, v200
    v_exp_f32 v201, v201
    v_exp_f32 v202, v202
    v_exp_f32 v203, v203
    v_cvt_pk_bf16_f32 v212, v200, v201
    v_cvt_pk_bf16_f32 v213, v202, v203
    v_mfma_f32_32x32x16_bf16 v[96:111], a[192:195], v[208:211], v[96:111]
    buffer_load_dwordx4 v21, s[16:19], s67 offen offset:2048 lds
    v_exp_f32 v204, v204
    v_exp_f32 v205, v205
    v_exp_f32 v206, v206
    v_exp_f32 v207, v207
    v_cvt_pk_bf16_f32 v214, v204, v205
    v_cvt_pk_bf16_f32 v215, v206, v207
    v_mfma_f32_32x32x16_bf16 v[192:207], a[36:39], a[6:9], 0
    s_mov_b32 s48, 3
    v_med3_f32 v169, v124, s6, v170
    v_rcp_f32 v168, v124
    v_cmp_neq_f32 vcc, v169, v124
    v_exp_f32 v176, v176
    v_exp_f32 v177, v177
    v_exp_f32 v178, v178
    v_exp_f32_e64 v179, v179
    v_cvt_pk_bf16_f32 v208, v176, v177
    v_cvt_pk_bf16_f32 v209, v178, v179
    v_pk_mul_f32 v[112:113], v[112:113], v[168:169] op_sel_hi:[1,0]
    v_pk_mul_f32 v[114:115], v[114:115], v[168:169] op_sel_hi:[1,0]
    v_pk_mul_f32 v[116:117], v[116:117], v[168:169] op_sel_hi:[1,0]
    v_pk_mul_f32 v[118:119], v[118:119], v[168:169] op_sel_hi:[1,0]
    v_pk_mul_f32 v[120:121], v[120:121], v[168:169] op_sel_hi:[1,0]
    v_pk_mul_f32 v[122:123], v[122:123], v[168:169] op_sel_hi:[1,0]
    v_cvt_pk_bf16_f32 v112, v112, v113
    v_cvt_pk_bf16_f32 v113, v114, v115
    v_cvt_pk_bf16_f32 v114, v116, v117
    v_cvt_pk_bf16_f32 v115, v118, v119
    v_cvt_pk_bf16_f32 v116, v120, v121
    v_cvt_pk_bf16_f32 v117, v122, v123
    v_mfma_f32_32x32x8_bf16 v[192:207], a[40:41], a[10:11], v[192:207]
    s_cbranch_vccnz L_slow
    v_exp_f32 v180, v180
    v_exp_f32 v181, v181
    v_exp_f32 v182, v182
    v_exp_f32_e64 v183, v183
    v_cvt_pk_bf16_f32 v210, v180, v181
    v_cvt_pk_bf16_f32 v211, v182, v183
    v_mfma_f32_32x32x16_bf16 v[96:111], a[196:199], v[212:215], v[96:111]
    buffer_store_dwordx4 v[112:115], v46, s[24:27], s53 offen sc1
    v_exp_f32 v184, v184
    v_exp_f32 v185, v185
    v_exp_f32 v186, v186
    v_exp_f32 v187, v187
    v_cvt_pk_bf16_f32 v212, v184, v185
    v_cvt_pk_bf16_f32 v213, v186, v187
    v_mfma_f32_32x32x16_bf16 v[80:95], a[216:219], v[208:211], v[80:95]
    buffer_store_dwordx2 v[116:117], v47, s[24:27], s53 offen sc1
    v_exp_f32 v188, v188
    v_exp_f32 v189, v189
    v_exp_f32 v190, v190
    v_exp_f32 v191, v191
    v_cvt_pk_bf16_f32 v214, v188, v189
    v_cvt_pk_bf16_f32 v215, v190, v191
    v_mfma_f32_32x32x16_bf16 v[176:191], a[66:69], a[6:9], 0
    buffer_load_dwordx4 v22, s[16:19], s67 offen offset:3072 lds
    v_exp_f32 v192, v192
    v_exp_f32 v193, v193
    v_exp_f32 v194, v194
    v_exp_f32 v195, v195
    v_cvt_pk_bf16_f32 v208, v192, v193
    v_cvt_pk_bf16_f32 v209, v194, v195
    v_mfma_f32_32x32x8_bf16 v[176:191], a[70:71], a[10:11], v[176:191]
    s_add_u32 m0, s63, 86016
    v_exp_f32 v196, v196
    v_exp_f32 v197, v197
    v_exp_f32 v198, v198
    v_exp_f32 v199, v199
    v_cvt_pk_bf16_f32 v210, v196, v197
    v_cvt_pk_bf16_f32 v211, v198, v199
    v_mfma_f32_32x32x16_bf16 v[80:95], a[220:223], v[212:215], v[80:95]
    s_mov_b32 s48, 2
    v_exp_f32 v200, v200
    v_exp_f32 v201, v201
    v_exp_f32 v202, v202
    v_exp_f32_e64 v203, v203
    v_cvt_pk_bf16_f32 v212, v200, v201
    v_cvt_pk_bf16_f32 v213, v202, v203
    v_mfma_f32_32x32x16_bf16 v[80:95], a[208:211], v[208:211], v[80:95]
    buffer_load_dwordx4 v23, s[16:19], s67 offen lds
    s_add_u32 m0, s63, 40960
    v_med3_f32 v169, v108, s6, v170
    v_rcp_f32 v168, v108
    v_cmp_neq_f32 vcc, v169, v108
    v_exp_f32 v204, v204
    v_exp_f32 v205, v205
    v_exp_f32 v206, v206
    v_exp_f32 v207, v207
    v_cvt_pk_bf16_f32 v214, v204, v205
    v_cvt_pk_bf16_f32 v215, v206, v207
    v_pk_mul_f32 v[96:97], v[96:97], v[168:169] op_sel_hi:[1,0]
    v_pk_mul_f32 v[98:99], v[98:99], v[168:169] op_sel_hi:[1,0]
    v_pk_mul_f32 v[100:101], v[100:101], v[168:169] op_sel_hi:[1,0]
    v_pk_mul_f32 v[102:103], v[102:103], v[168:169] op_sel_hi:[1,0]
    v_pk_mul_f32 v[104:105], v[104:105], v[168:169] op_sel_hi:[1,0]
    v_pk_mul_f32 v[106:107], v[106:107], v[168:169] op_sel_hi:[1,0]
    v_cvt_pk_bf16_f32 v96, v96, v97
    v_cvt_pk_bf16_f32 v97, v98, v99
    v_cvt_pk_bf16_f32 v98, v100, v101
    v_cvt_pk_bf16_f32 v99, v102, v103
    v_cvt_pk_bf16_f32 v100, v104, v105
    v_cvt_pk_bf16_f32 v101, v106, v107
    v_mfma_f32_32x32x16_bf16 v[192:207], a[60:63], a[6:9], 0
    s_cbranch_vccnz L_slow
    buffer_store_dwordx4 v[96:99], v46, s[24:27], s1 offen sc1
    buffer_store_dwordx2 v[100:101], v47, s[24:27], s1 offen sc1
    v_exp_f32 v176, v176
    v_exp_f32 v177, v177
    v_exp_f32 v178, v178
    v_exp_f32_e64 v179, v179
    v_cvt_pk_bf16_f32 v208, v176, v177
    v_cvt_pk_bf16_f32 v209, v178, v179
    v_mfma_f32_32x32x8_bf16 v[192:207], a[64:65], a[10:11], v[192:207]
    buffer_load_dwordx4 v19, s[16:19], s100 offen offset:0 lds
    v_exp_f32 v180, v180
    v_exp_f32 v181, v181
    v_exp_f32 v182, v182
    v_exp_f32 v183, v183
    v_cvt_pk_bf16_f32 v210, v180, v181
    v_cvt_pk_bf16_f32 v211, v182, v183
    v_mfma_f32_32x32x16_bf16 v[80:95], a[212:215], v[212:215], v[80:95]
    buffer_load_dwordx4 v20, s[16:19], s100 offen offset:1024 lds
    v_exp_f32 v184, v184
    v_exp_f32 v185, v185
    v_exp_f32 v186, v186
    v_exp_f32 v187, v187
    v_cvt_pk_bf16_f32 v212, v184, v185
    v_cvt_pk_bf16_f32 v213, v186, v187
    v_mfma_f32_32x32x16_bf16 v[80:95], a[248:251], v[208:211], v[80:95]
    v_exp_f32 v188, v188
    v_exp_f32 v189, v189
    v_exp_f32 v190, v190
    v_exp_f32 v191, v191
    v_cvt_pk_bf16_f32 v214, v188, v189
    v_cvt_pk_bf16_f32 v215, v190, v191
    v_mfma_f32_32x32x16_bf16 v[176:191], a[30:33], a[6:9], 0
    v_exp_f32 v192, v192
    v_exp_f32 v193, v193
    v_exp_f32 v194, v194
    v_exp_f32 v195, v195
    v_cvt_pk_bf16_f32 v208, v192, v193
    v_cvt_pk_bf16_f32 v209, v194, v195
    v_mfma_f32_32x32x8_bf16 v[176:191], a[34:35], a[10:11], v[176:191]
    buffer_load_dwordx4 v21, s[16:19], s100 offen offset:2048 lds
    v_exp_f32 v196, v196
    v_exp_f32 v197, v197
    v_exp_f32 v198, v198
    v_exp_f32 v199, v199
    v_cvt_pk_bf16_f32 v210, v196, v197
    v_cvt_pk_bf16_f32 v211, v198, v199
    v_mfma_f32_32x32x16_bf16 v[80:95], a[252:255], v[212:215], v[80:95]
    v_exp_f32 v200, v200
    v_exp_f32 v201, v201
    v_exp_f32 v202, v202
    v_exp_f32 v203, v203
    v_cvt_pk_bf16_f32 v212, v200, v201
    v_cvt_pk_bf16_f32 v213, v202, v203
    v_mfma_f32_32x32x16_bf16 v[80:95], a[240:243], v[208:211], v[80:95]
    buffer_load_dwordx4 v22, s[16:19], s100 offen offset:3072 lds
    v_exp_f32 v204, v204
    v_exp_f32 v205, v205
    v_exp_f32 v206, v206
    v_exp_f32 v207, v207
    v_cvt_pk_bf16_f32 v214, v204, v205
    v_cvt_pk_bf16_f32 v215, v206, v207
    v_mfma_f32_32x32x16_bf16 v[192:207], a[24:27], a[6:9], 0
    s_add_u32 m0, s63, 45056
    v_exp_f32 v176, v176
    v_exp_f32 v177, v177
    v_exp_f32 v178, v178
    v_exp_f32 v179, v179
    v_cvt_pk_bf16_f32 v208, v176, v177
    v_cvt_pk_bf16_f32 v209, v178, v179
    v_mfma_f32_32x32x8_bf16 v[192:207], a[28:29], a[10:11], v[192:207]
    s_waitcnt vmcnt(4)
    v_exp_f32 v180, v180
    v_exp_f32 v181, v181
    v_exp_f32 v182, v182
    v_exp_f32_e64 v183, v183
    v_cvt_pk_bf16_f32 v210, v180, v181
    v_cvt_pk_bf16_f32 v211, v182, v183
    v_mfma_f32_32x32x16_bf16 v[80:95], a[244:247], v[212:215], v[80:95]
    buffer_store_dwordx4 v[58:61], v60, s[24:27], 0 offen offset:384 sc1
    v_exp_f32 v184, v184
    v_exp_f32 v185, v185
    v_exp_f32 v186, v186
    v_exp_f32 v187, v187
    v_cvt_pk_bf16_f32 v212, v184, v185
    v_cvt_pk_bf16_f32 v213, v186, v187
    v_mfma_f32_32x32x16_bf16 v[80:95], a[200:203], v[208:211], v[80:95]
    buffer_load_dwordx4 v23, s[16:19], s100 offen lds
    v_exp_f32 v188, v188
    v_exp_f32 v189, v189
    v_exp_f32 v190, v190
    v_exp_f32 v191, v191
    v_cvt_pk_bf16_f32 v214, v188, v189
    v_cvt_pk_bf16_f32 v215, v190, v191
    v_mfma_f32_32x32x16_bf16 v[176:191], a[54:57], a[6:9], v[240:255]
    s_add_u32 m0, s63, 0
    v_exp_f32 v192, v192
    v_exp_f32 v193, v193
    v_exp_f32 v194, v194
    v_exp_f32_e64 v195, v195
    v_cvt_pk_bf16_f32 v208, v192, v193
    v_cvt_pk_bf16_f32 v209, v194, v195
    v_mfma_f32_32x32x8_bf16 v[176:191], a[58:59], a[10:11], v[176:191]
    buffer_load_dwordx4 v19, s[16:19], s4 offen offset:0 lds
    v_exp_f32 v196, v196
    v_exp_f32 v197, v197
    v_exp_f32 v198, v198
    v_exp_f32 v199, v199
    v_cvt_pk_bf16_f32 v210, v196, v197
    v_cvt_pk_bf16_f32 v211, v198, v199
    v_mfma_f32_32x32x16_bf16 v[80:95], a[204:207], v[212:215], v[80:95]
    v_exp_f32 v200, v200
    v_exp_f32 v201, v201
    v_exp_f32 v202, v202
    v_exp_f32 v203, v203
    v_cvt_pk_bf16_f32 v212, v200, v201
    v_cvt_pk_bf16_f32 v213, v202, v203
    v_mfma_f32_32x32x16_bf16 v[80:95], a[192:195], v[208:211], v[80:95]
    buffer_load_dwordx4 v20, s[16:19], s4 offen offset:1024 lds
    v_exp_f32 v204, v204
    v_exp_f32 v205, v205
    v_exp_f32 v206, v206
    v_exp_f32 v207, v207
    v_cvt_pk_bf16_f32 v214, v204, v205
    v_cvt_pk_bf16_f32 v215, v206, v207
    v_mfma_f32_32x32x16_bf16 v[192:207], v[216:219], a[0:3], v[144:159]
    v_exp_f32 v176, v176
    v_exp_f32 v177, v177
    v_exp_f32 v178, v178
    v_exp_f32 v179, v179
    v_cvt_pk_bf16_f32 v208, v176, v177
    v_cvt_pk_bf16_f32 v209, v178, v179
    v_mfma_f32_32x32x8_bf16 v[192:207], v[220:221], a[4:5], v[192:207]
    v_exp_f32 v180, v180
    v_exp_f32 v181, v181
    v_exp_f32 v182, v182
    v_exp_f32 v183, v183
    v_cvt_pk_bf16_f32 v210, v180, v181
    v_cvt_pk_bf16_f32 v211, v182, v183
    v_mfma_f32_32x32x16_bf16 v[80:95], a[196:199], v[212:215], v[80:95]
    buffer_load_dwordx4 v21, s[16:19], s4 offen offset:2048 lds
    v_exp_f32 v184, v184
    v_exp_f32 v185, v185
    v_exp_f32 v186, v186
    v_exp_f32 v187, v187
    v_cvt_pk_bf16_f32 v212, v184, v185
    v_cvt_pk_bf16_f32 v213, v186, v187
    v_mfma_f32_32x32x16_bf16 v[80:95], a[232:235], v[208:211], v[80:95]
    v_exp_f32 v188, v188
    v_exp_f32 v189, v189
    v_exp_f32 v190, v190
    v_exp_f32 v191, v191
    v_cvt_pk_bf16_f32 v214, v188, v189
    v_cvt_pk_bf16_f32 v215, v190, v191
    v_mfma_f32_32x32x16_bf16 v[176:191], a[42:45], a[0:3], 0
    v_exp_f32 v192, v192
    v_exp_f32 v193, v193
    v_exp_f32 v194, v194
    v_exp_f32 v195, v195
    v_cvt_pk_bf16_f32 v208, v192, v193
    v_cvt_pk_bf16_f32 v209, v194, v195
    v_mfma_f32_32x32x8_bf16 v[176:191], a[46:47], a[4:5], v[176:191]
    buffer_load_dwordx4 v22, s[16:19], s4 offen offset:3072 lds
    v_exp_f32 v196, v196
    v_exp_f32 v197, v197
    v_exp_f32 v198, v198
    v_exp_f32 v199, v199
    v_cvt_pk_bf16_f32 v210, v196, v197
    v_cvt_pk_bf16_f32 v211, v198, v199
    v_mfma_f32_32x32x16_bf16 v[80:95], a[236:239], v[212:215], v[80:95]
    s_add_u32 m0, s63, 4096
    v_exp_f32 v200, v200
    v_exp_f32 v201, v201
    v_exp_f32 v202, v202
    v_exp_f32 v203, v203
    v_cvt_pk_bf16_f32 v212, v200, v201
    v_cvt_pk_bf16_f32 v213, v202, v203
    v_mfma_f32_32x32x16_bf16 v[64:79], a[160:163], v[208:211], 0
    buffer_load_dwordx4 v23, s[16:19], s4 offen lds
    v_exp_f32 v204, v204
    v_exp_f32 v205, v205
    v_exp_f32 v206, v206
    v_exp_f32 v207, v207
    v_cvt_pk_bf16_f32 v214, v204, v205
    v_cvt_pk_bf16_f32 v215, v206, v207
    v_mfma_f32_32x32x16_bf16 v[192:207], a[36:39], a[0:3], 0
    s_add_u32 m0, s63, 20480
    v_exp_f32 v176, v176
    v_exp_f32 v177, v177
    v_exp_f32 v178, v178
    v_exp_f32 v179, v179
    v_cvt_pk_bf16_f32 v208, v176, v177
    v_cvt_pk_bf16_f32 v209, v178, v179
    v_mfma_f32_32x32x8_bf16 v[192:207], a[40:41], a[4:5], v[192:207]
    s_mov_b32 s48, 1
    v_med3_f32 v169, v92, s6, v170
    v_rcp_f32 v168, v92
    v_cmp_neq_f32 vcc, v169, v92
    v_exp_f32 v180, v180
    v_exp_f32 v181, v181
    v_exp_f32 v182, v182
    v_exp_f32_e64 v183, v183
    v_cvt_pk_bf16_f32 v210, v180, v181
    v_cvt_pk_bf16_f32 v211, v182, v183
    v_pk_mul_f32 v[80:81], v[80:81], v[168:169] op_sel_hi:[1,0]
    v_pk_mul_f32 v[82:83], v[82:83], v[168:169] op_sel_hi:[1,0]
    v_pk_mul_f32 v[84:85], v[84:85], v[168:169] op_sel_hi:[1,0]
    v_pk_mul_f32 v[86:87], v[86:87], v[168:169] op_sel_hi:[1,0]
    v_pk_mul_f32 v[88:89], v[88:89], v[168:169] op_sel_hi:[1,0]
    v_pk_mul_f32 v[90:91], v[90:91], v[168:169] op_sel_hi:[1,0]
    v_cvt_pk_bf16_f32 v80, v80, v81
    v_cvt_pk_bf16_f32 v81, v82, v83
    v_cvt_pk_bf16_f32 v82, v84, v85
    v_cvt_pk_bf16_f32 v83, v86, v87
    v_cvt_pk_bf16_f32 v84, v88, v89
    v_cvt_pk_bf16_f32 v85, v90, v91
    v_mfma_f32_32x32x16_bf16 v[64:79], a[164:167], v[212:215], v[64:79]
    s_cbranch_vccnz L_slow
    v_exp_f32 v184, v184
    v_exp_f32 v185, v185
    v_exp_f32 v186, v186
    v_exp_f32_e64 v187, v187
    v_cvt_pk_bf16_f32 v212, v184, v185
    v_cvt_pk_bf16_f32 v213, v186, v187
    v_mfma_f32_32x32x16_bf16 v[64:79], a[216:219], v[208:211], v[64:79]
    buffer_store_dwordx4 v[80:83], v46, s[24:27], s0 offen sc1
    buffer_store_dwordx2 v[84:85], v47, s[24:27], s0 offen sc1
    v_exp_f32 v188, v188
    v_exp_f32 v189, v189
    v_exp_f32 v190, v190
    v_exp_f32 v191, v191
    v_cvt_pk_bf16_f32 v214, v188, v189
    v_cvt_pk_bf16_f32 v215, v190, v191
    v_mfma_f32_32x32x16_bf16 v[176:191], a[66:69], a[0:3], 0
    buffer_load_dwordx4 v19, s[16:19], s5 offen offset:0 lds
    v_exp_f32 v192, v192
    v_exp_f32 v193, v193
    v_exp_f32 v194, v194
    v_exp_f32 v195, v195
    v_cvt_pk_bf16_f32 v208, v192, v193
    v_cvt_pk_bf16_f32 v209, v194, v195
    v_mfma_f32_32x32x8_bf16 v[176:191], a[70:71], a[4:5], v[176:191]
    buffer_load_dwordx4 v20, s[16:19], s5 offen offset:1024 lds
    v_exp_f32 v196, v196
    v_exp_f32 v197, v197
    v_exp_f32 v198, v198
    v_exp_f32 v199, v199
    v_cvt_pk_bf16_f32 v210, v196, v197
    v_cvt_pk_bf16_f32 v211, v198, v199
    v_mfma_f32_32x32x16_bf16 v[64:79], a[220:223], v[212:215], v[64:79]
    buffer_load_dword v11, v61, s[24:27], 0 offen offset:384 sc1
    v_exp_f32 v200, v200
    v_exp_f32 v201, v201
    v_exp_f32 v202, v202
    v_exp_f32 v203, v203
    v_cvt_pk_bf16_f32 v212, v200, v201
    v_cvt_pk_bf16_f32 v213, v202, v203
    v_mfma_f32_32x32x16_bf16 v[64:79], a[208:211], v[208:211], v[64:79]
    v_exp_f32 v204, v204
    v_exp_f32 v205, v205
    v_exp_f32 v206, v206
    v_exp_f32 v207, v207
    v_cvt_pk_bf16_f32 v214, v204, v205
    v_cvt_pk_bf16_f32 v215, v206, v207
    v_mfma_f32_32x32x16_bf16 v[192:207], a[60:63], a[0:3], 0
    buffer_load_dwordx4 v21, s[16:19], s5 offen offset:2048 lds
    v_exp_f32 v176, v176
    v_exp_f32 v177, v177
    v_exp_f32 v178, v178
    v_exp_f32 v179, v179
    v_cvt_pk_bf16_f32 v208, v176, v177
    v_cvt_pk_bf16_f32 v209, v178, v179
    v_mfma_f32_32x32x8_bf16 v[192:207], a[64:65], a[4:5], v[192:207]
    v_exp_f32 v180, v180
    v_exp_f32 v181, v181
    v_exp_f32 v182, v182
    v_exp_f32 v183, v183
    v_cvt_pk_bf16_f32 v210, v180, v181
    v_cvt_pk_bf16_f32 v211, v182, v183
    v_mfma_f32_32x32x16_bf16 v[64:79], a[212:215], v[212:215], v[64:79]
    buffer_load_dwordx4 v22, s[16:19], s5 offen offset:3072 lds
    v_exp_f32 v184, v184
    v_exp_f32 v185, v185
    v_exp_f32 v186, v186
    v_exp_f32 v187, v187
    v_cvt_pk_bf16_f32 v212, v184, v185
    v_cvt_pk_bf16_f32 v213, v186, v187
    v_mfma_f32_32x32x16_bf16 v[64:79], a[248:251], v[208:211], v[64:79]
    s_add_u32 m0, s63, 24576
    v_exp_f32 v188, v188
    v_exp_f32 v189, v189
    v_exp_f32 v190, v190
    v_exp_f32 v191, v191
    v_cvt_pk_bf16_f32 v214, v188, v189
    v_cvt_pk_bf16_f32 v215, v190, v191
    v_mfma_f32_32x32x16_bf16 v[176:191], a[30:33], a[0:3], 0
    v_exp_f32 v192, v192
    v_exp_f32 v193, v193
    v_exp_f32 v194, v194
    v_exp_f32 v195, v195
    v_cvt_pk_bf16_f32 v208, v192, v193
    v_cvt_pk_bf16_f32 v209, v194, v195
    v_mfma_f32_32x32x8_bf16 v[176:191], a[34:35], a[4:5], v[176:191]
    buffer_load_dwordx4 v23, s[16:19], s5 offen lds
    v_exp_f32 v196, v196
    v_exp_f32 v197, v197
    v_exp_f32 v198, v198
    v_exp_f32 v199, v199
    v_cvt_pk_bf16_f32 v210, v196, v197
    v_cvt_pk_bf16_f32 v211, v198, v199
    v_mfma_f32_32x32x16_bf16 v[64:79], a[252:255], v[212:215], v[64:79]
    v_exp_f32 v200, v200
    v_exp_f32 v201, v201
    v_exp_f32 v202, v202
    v_exp_f32 v203, v203
    v_cvt_pk_bf16_f32 v212, v200, v201
    v_cvt_pk_bf16_f32 v213, v202, v203
    v_mfma_f32_32x32x16_bf16 v[64:79], a[240:243], v[208:211], v[64:79]
    v_exp_f32 v204, v204
    v_exp_f32 v205, v205
    v_exp_f32 v206, v206
    v_exp_f32 v207, v207
    v_cvt_pk_bf16_f32 v214, v204, v205
    v_cvt_pk_bf16_f32 v215, v206, v207
    v_mfma_f32_32x32x16_bf16 v[192:207], a[24:27], a[0:3], 0
    s_waitcnt vmcnt(6)
    v_exp_f32 v176, v176
    v_exp_f32 v177, v177
    v_exp_f32 v178, v178
    v_exp_f32_e64 v179, v179
    v_cvt_pk_bf16_f32 v208, v176, v177
    v_cvt_pk_bf16_f32 v209, v178, v179
    v_mfma_f32_32x32x8_bf16 v[192:207], a[28:29], a[4:5], v[192:207]
    buffer_store_dwordx4 v[58:61], v60, s[24:27], 0 offen offset:256 sc1
    v_exp_f32 v180, v180
    v_exp_f32 v181, v181
    v_exp_f32 v182, v182
    v_exp_f32 v183, v183
    v_cvt_pk_bf16_f32 v210, v180, v181
    v_cvt_pk_bf16_f32 v211, v182, v183
    v_mfma_f32_32x32x16_bf16 v[64:79], a[244:247], v[212:215], v[64:79]
    v_exp_f32 v184, v184
    v_exp_f32 v185, v185
    v_exp_f32 v186, v186
    v_exp_f32 v187, v187
    v_cvt_pk_bf16_f32 v212, v184, v185
    v_cvt_pk_bf16_f32 v213, v186, v187
    v_mfma_f32_32x32x16_bf16 v[64:79], a[200:203], v[208:211], v[64:79]
    v_exp_f32 v188, v188
    v_exp_f32 v189, v189
    v_exp_f32 v190, v190
    v_exp_f32 v191, v191
    v_cvt_pk_bf16_f32 v214, v188, v189
    v_cvt_pk_bf16_f32 v215, v190, v191
    v_mfma_f32_32x32x16_bf16 v[176:191], a[54:57], a[0:3], 0
    s_waitcnt vmcnt(4)
    v_cmp_ne_u32 vcc, s66, v11
    v_exp_f32 v192, v192
    v_exp_f32 v193, v193
    v_exp_f32 v194, v194
    v_exp_f32 v195, v195
    v_cvt_pk_bf16_f32 v208, v192, v193
    v_cvt_pk_bf16_f32 v209, v194, v195
    v_mfma_f32_32x32x8_bf16 v[176:191], a[58:59], a[4:5], v[176:191]
    s_cbranch_vccnz L_spin_5
L_ok_6:
    v_exp_f32 v196, v196
    v_exp_f32 v197, v197
    v_exp_f32 v198, v198
    v_exp_f32_e64 v199, v199
    v_cvt_pk_bf16_f32 v210, v196, v197
    v_cvt_pk_bf16_f32 v211, v198, v199
    v_mfma_f32_32x32x16_bf16 v[64:79], a[204:207], v[212:215], v[64:79]
    buffer_load_dwordx4 v[128:131], v54, s[24:27], s53 offen offset:0 sc1
    v_exp_f32 v200, v200
    v_exp_f32 v201, v201
    v_exp_f32 v202, v202
    v_exp_f32 v203, v203
    v_cvt_pk_bf16_f32 v212, v200, v201
    v_cvt_pk_bf16_f32 v213, v202, v203
    v_mfma_f32_32x32x16_bf16 v[64:79], a[192:195], v[208:211], v[64:79]
    buffer_load_dwordx4 v[132:135], v54, s[24:27], s53 offen offset:1024 sc1
    v_exp_f32 v204, v204
    v_exp_f32 v205, v205
    v_exp_f32 v206, v206
    v_exp_f32 v207, v207
    v_cvt_pk_bf16_f32 v214, v204, v205
    v_cvt_pk_bf16_f32 v215, v206, v207
    v_mfma_f32_32x32x16_bf16 v[192:207], a[48:51], a[0:3], v[240:255]
    buffer_load_dwordx4 v[136:139], v54, s[24:27], s53 offen offset:2048 sc1
    v_exp_f32 v176, v176
    v_exp_f32 v177, v177
    v_exp_f32 v178, v178
    v_exp_f32 v179, v179
    v_cvt_pk_bf16_f32 v208, v176, v177
    v_cvt_pk_bf16_f32 v209, v178, v179
    v_mfma_f32_32x32x8_bf16 v[192:207], a[52:53], a[4:5], v[192:207]
    buffer_load_dwordx4 v[140:143], v54, s[24:27], s53 offen offset:3072 sc1
    v_exp_f32 v180, v180
    v_exp_f32 v181, v181
    v_exp_f32 v182, v182
    v_exp_f32 v183, v183
    v_cvt_pk_bf16_f32 v210, v180, v181
    v_cvt_pk_bf16_f32 v211, v182, v183
    v_mfma_f32_32x32x16_bf16 v[64:79], a[196:199], v[212:215], v[64:79]
    s_waitcnt vmcnt(5)
    s_barrier
    v_exp_f32 v184, v184
    v_exp_f32 v185, v185
    v_exp_f32 v186, v186
    v_exp_f32 v187, v187
    v_cvt_pk_bf16_f32 v212, v184, v185
    v_cvt_pk_bf16_f32 v213, v186, v187
    v_mfma_f32_32x32x16_bf16 v[64:79], a[232:235], v[208:211], v[64:79]
    buffer_load_dwordx2 v[144:145], v0, s[24:27], s53 offen offset:0 sc1
    v_exp_f32 v188, v188
    v_exp_f32 v189, v189
    v_exp_f32 v190, v190
    v_exp_f32 v191, v191
    v_cvt_pk_bf16_f32 v214, v188, v189
    v_cvt_pk_bf16_f32 v215, v190, v191
    buffer_load_dwordx2 v[146:147], v0, s[24:27], s53 offen offset:256 sc1
    v_exp_f32 v192, v192
    v_exp_f32 v193, v193
    v_exp_f32 v194, v194
    v_exp_f32 v195, v195
    v_cvt_pk_bf16_f32 v208, v192, v193
    v_cvt_pk_bf16_f32 v209, v194, v195
    buffer_load_dwordx4 v[148:151], v55, s[24:27], s53 offen offset:0 sc1
    v_exp_f32 v196, v196
    v_exp_f32 v197, v197
    v_exp_f32 v198, v198
    v_exp_f32 v199, v199
    v_cvt_pk_bf16_f32 v210, v196, v197
    v_cvt_pk_bf16_f32 v211, v198, v199
    v_mfma_f32_32x32x16_bf16 v[64:79], a[236:239], v[212:215], v[64:79]
    buffer_load_dwordx4 v[152:155], v55, s[24:27], s53 offen offset:1024 sc1
    v_exp_f32 v200, v200
    v_exp_f32 v201, v201
    v_exp_f32 v202, v202
    v_exp_f32 v203, v203
    v_cvt_pk_bf16_f32 v212, v200, v201
    v_cvt_pk_bf16_f32 v213, v202, v203
    v_mfma_f32_32x32x16_bf16 v[64:79], a[224:227], v[208:211], v[64:79]
    s_mov_b32 s48, 0
    buffer_load_dwordx4 v[156:159], v55, s[24:27], s53 offen offset:2048 sc1
    v_exp_f32 v204, v204
    v_exp_f32 v205, v205
    v_exp_f32 v206, v206
    v_exp_f32_e64 v207, v207
    v_cvt_pk_bf16_f32 v214, v204, v205
    v_cvt_pk_bf16_f32 v215, v206, v207
    buffer_load_dwordx4 v[160:163], v55, s[24:27], s53 offen offset:3072 sc1
    buffer_load_dwordx2 v[164:165], v59, s[24:27], s53 offen offset:0 sc1
    buffer_load_dwordx2 v[166:167], v59, s[24:27], s53 offen offset:256 sc1
    s_nop 1
    v_mfma_f32_32x32x16_bf16 v[64:79], a[228:231], v[212:215], v[64:79]
    ds_read_b64_tr_b16 v[216:217], v48 offset:0
    ds_read_b64_tr_b16 v[218:219], v48 offset:1280
    ds_read_b64_tr_b16 v[220:221], v48 offset:8
    ds_read_b64_tr_b16 v[222:223], v48 offset:1288
    ds_read_b64_tr_b16 v[224:225], v48 offset:16
    ds_read_b64_tr_b16 v[226:227], v48 offset:1296
    ds_read_b64_tr_b16 v[228:229], v48 offset:24
    ds_read_b64_tr_b16 v[230:231], v48 offset:1304
    ds_read_b64_tr_b16 v[232:233], v48 offset:32
    ds_read_b64_tr_b16 v[234:235], v48 offset:1312
    ds_read_b64_tr_b16 v[236:237], v48 offset:6400
    ds_read_b64_tr_b16 v[238:239], v48 offset:7680
    ds_read_b64_tr_b16 a[152:153], v48 offset:6408
    ds_read_b64_tr_b16 a[154:155], v48 offset:7688
    v_med3_f32 v169, v76, s6, v170
    v_rcp_f32 v168, v76
    v_cmp_neq_f32 vcc, v169, v76
    v_pk_mul_f32 v[64:65], v[64:65], v[168:169] op_sel_hi:[1,0]
    v_pk_mul_f32 v[66:67], v[66:67], v[168:169] op_sel_hi:[1,0]
    v_pk_mul_f32 v[68:69], v[68:69], v[168:169] op_sel_hi:[1,0]
    v_pk_mul_f32 v[70:71], v[70:71], v[168:169] op_sel_hi:[1,0]
    v_pk_mul_f32 v[72:73], v[72:73], v[168:169] op_sel_hi:[1,0]
    v_pk_mul_f32 v[74:75], v[74:75], v[168:169] op_sel_hi:[1,0]
    v_cvt_pk_bf16_f32 v64, v64, v65
    v_cvt_pk_bf16_f32 v65, v66, v67
    v_cvt_pk_bf16_f32 v66, v68, v69
    v_cvt_pk_bf16_f32 v67, v70, v71
    v_cvt_pk_bf16_f32 v68, v72, v73
    v_cvt_pk_bf16_f32 v69, v74, v75
    s_cbranch_vccnz L_slow
    buffer_store_dwordx4 v[64:67], v46, s[24:27], 0 offen sc1
    buffer_store_dwordx2 v[68:69], v47, s[24:27], 0 offen sc1
L_join:
    s_waitcnt vmcnt(13) lgkmcnt(10)
    v_mfma_f32_16x16x32_bf16 v[80:83], v[216:219], v[128:131], 0
    ds_read_b64_tr_b16 a[156:157], v48 offset:6416
    ds_read_b64_tr_b16 a[158:159], v48 offset:7696
    v_mfma_f32_16x16x32_bf16 v[84:87], v[220:223], v[128:131], 0
    ds_read_b64_tr_b16 a[160:161], v48 offset:6424
    ds_read_b64_tr_b16 a[162:163], v48 offset:7704
    s_waitcnt lgkmcnt(10)
    v_mfma_f32_16x16x32_bf16 v[88:91], v[224:227], v[128:131], 0
    ds_read_b64_tr_b16 a[164:165], v48 offset:6432
    ds_read_b64_tr_b16 a[166:167], v48 offset:7712
    v_mfma_f32_16x16x32_bf16 v[92:95], v[228:231], v[128:131], 0
    ds_read_b64_tr_b16 a[168:169], v48 offset:12800
    ds_read_b64_tr_b16 a[170:171], v48 offset:14080
    s_waitcnt lgkmcnt(10)
    v_mfma_f32_16x16x32_bf16 v[96:99], v[232:235], v[128:131], 0
    ds_read_b64_tr_b16 a[172:173], v48 offset:12808
    ds_read_b64_tr_b16 a[174:175], v48 offset:14088
    s_waitcnt vmcnt(12)
    v_mfma_f32_16x16x32_bf16 v[80:83], v[236:239], v[132:135], v[80:83]
    ds_read_b64_tr_b16 a[176:177], v48 offset:12816
    ds_read_b64_tr_b16 a[178:179], v48 offset:14096
    s_waitcnt lgkmcnt(10)
    v_mfma_f32_16x16x32_bf16 v[84:87], a[152:155], v[132:135], v[84:87]
    ds_read_b64_tr_b16 a[180:181], v48 offset:12824
    ds_read_b64_tr_b16 a[182:183], v48 offset:14104
    v_mfma_f32_16x16x32_bf16 v[88:91], a[156:159], v[132:135], v[88:91]
    ds_read_b64_tr_b16 a[184:185], v48 offset:12832
    ds_read_b64_tr_b16 a[186:187], v48 offset:14112
    s_waitcnt lgkmcnt(10)
    v_mfma_f32_16x16x32_bf16 v[92:95], a[160:163], v[132:135], v[92:95]
    ds_read_b64_tr_b16 a[188:189], v48 offset:19200
    ds_read_b64_tr_b16 a[190:191], v48 offset:20480
    buffer_load_dwordx4 a[72:75], v54, s[24:27], s1 offen offset:0 sc1
    v_mfma_f32_16x16x32_bf16 v[96:99], a[164:167], v[132:135], v[96:99]
    ds_read_b64_tr_b16 a[192:193], v48 offset:19208
    ds_read_b64_tr_b16 a[194:195], v48 offset:20488
    s_waitcnt vmcnt(12) lgkmcnt(10)
    v_mfma_f32_16x16x32_bf16 v[80:83], a[168:171], v[136:139], v[80:83]
    ds_read_b64_tr_b16 a[196:197], v48 offset:19216
    ds_read_b64_tr_b16 a[198:199], v48 offset:20496
    v_mfma_f32_16x16x32_bf16 v[84:87], a[172:175], v[136:139], v[84:87]
    ds_read_b64_tr_b16 a[200:201], v48 offset:19224
    ds_read_b64_tr_b16 a[202:203], v48 offset:20504
    s_waitcnt lgkmcnt(10)
    v_mfma_f32_16x16x32_bf16 v[88:91], a[176:179], v[136:139], v[88:91]
    ds_read_b64_tr_b16 a[204:205], v48 offset:19232
    ds_read_b64_tr_b16 a[206:207], v48 offset:20512
    buffer_load_dwordx4 a[76:79], v54, s[24:27], s1 offen offset:1024 sc1
    v_mfma_f32_16x16x32_bf16 v[92:95], a[180:183], v[136:139], v[92:95]
    ds_read_b64_tr_b16 a[208:209], v49 offset:2560
    ds_read_b64_tr_b16 a[210:211], v49 offset:8960
    s_waitcnt lgkmcnt(10)
    v_mfma_f32_16x16x32_bf16 v[96:99], a[184:187], v[136:139], v[96:99]
    ds_read_b64_tr_b16 a[212:213], v49 offset:2568
    ds_read_b64_tr_b16 a[214:215], v49 offset:8968
    s_waitcnt vmcnt(12)
    v_mfma_f32_16x16x32_bf16 v[80:83], a[188:191], v[140:143], v[80:83]
    ds_read_b64_tr_b16 a[216:217], v49 offset:2576
    ds_read_b64_tr_b16 a[218:219], v49 offset:8976
    s_waitcnt lgkmcnt(10)
    v_mfma_f32_16x16x32_bf16 v[84:87], a[192:195], v[140:143], v[84:87]
    ds_read_b64_tr_b16 a[220:221], v49 offset:2584
    ds_read_b64_tr_b16 a[222:223], v49 offset:8984
    buffer_load_dwordx4 a[80:83], v54, s[24:27], s1 offen offset:2048 sc1
    v_mfma_f32_16x16x32_bf16 v[88:91], a[196:199], v[140:143], v[88:91]
    ds_read_b64_tr_b16 a[224:225], v49 offset:2592
    ds_read_b64_tr_b16 a[226:227], v49 offset:8992
    s_waitcnt lgkmcnt(10)
    v_mfma_f32_16x16x32_bf16 v[92:95], a[200:203], v[140:143], v[92:95]
    ds_read_b64_tr_b16 a[228:229], v48 offset:25600
    ds_read_b64_tr_b16 a[230:231], v48 offset:26880
    v_mfma_f32_16x16x32_bf16 v[96:99], a[204:207], v[140:143], v[96:99]
    ds_read_b64_tr_b16 a[232:233], v48 offset:25608
    ds_read_b64_tr_b16 a[234:235], v48 offset:26888
    s_waitcnt vmcnt(11) lgkmcnt(10)
    v_mfma_f32_16x16x32_bf16 v[80:83], a[208:211], v[144:147], v[80:83]
    ds_read_b64_tr_b16 a[236:237], v48 offset:25616
    ds_read_b64_tr_b16 a[238:239], v48 offset:26896
    buffer_load_dwordx4 a[84:87], v54, s[24:27], s1 offen offset:3072 sc1
    v_mfma_f32_16x16x32_bf16 v[84:87], a[212:215], v[144:147], v[84:87]
    ds_read_b64_tr_b16 a[240:241], v48 offset:25624
    ds_read_b64_tr_b16 a[242:243], v48 offset:26904
    s_waitcnt lgkmcnt(10)
    v_mfma_f32_16x16x32_bf16 v[88:91], a[216:219], v[144:147], v[88:91]
    ds_read_b64_tr_b16 a[244:245], v48 offset:25632
    ds_read_b64_tr_b16 a[246:247], v48 offset:26912
    v_mfma_f32_16x16x32_bf16 v[92:95], a[220:223], v[144:147], v[92:95]
    ds_read_b64_tr_b16 a[248:249], v48 offset:32000
    ds_read_b64_tr_b16 a[250:251], v48 offset:33280
    s_waitcnt lgkmcnt(10)
    v_mfma_f32_16x16x32_bf16 v[96:99], a[224:227], v[144:147], v[96:99]
    ds_read_b64_tr_b16 a[252:253], v48 offset:32008
    ds_read_b64_tr_b16 a[254:255], v48 offset:33288
    buffer_load_dwordx2 a[88:89], v0, s[24:27], s1 offen offset:0 sc1
    s_waitcnt vmcnt(12)
    v_mfma_f32_16x16x32_bf16 v[80:83], a[228:231], v[148:151], v[80:83]
    ds_read_b64_tr_b16 a[0:1], v48 offset:32016
    ds_read_b64_tr_b16 a[2:3], v48 offset:33296
    s_waitcnt lgkmcnt(10)
    v_mfma_f32_16x16x32_bf16 v[84:87], a[232:235], v[148:151], v[84:87]
    ds_read_b64_tr_b16 a[4:5], v48 offset:32024
    ds_read_b64_tr_b16 a[6:7], v48 offset:33304
    v_mfma_f32_16x16x32_bf16 v[88:91], a[236:239], v[148:151], v[88:91]
    ds_read_b64_tr_b16 a[8:9], v48 offset:32032
    ds_read_b64_tr_b16 a[10:11], v48 offset:33312
    s_waitcnt lgkmcnt(10)
    v_mfma_f32_16x16x32_bf16 v[92:95], a[240:243], v[148:151], v[92:95]
    ds_read_b64_tr_b16 a[12:13], v48 offset:38400
    ds_read_b64_tr_b16 a[14:15], v48 offset:39680
    buffer_load_dwordx2 a[90:91], v0, s[24:27], s1 offen offset:256 sc1
    v_mfma_f32_16x16x32_bf16 v[96:99], a[244:247], v[148:151], v[96:99]
    ds_read_b64_tr_b16 a[16:17], v48 offset:38408
    ds_read_b64_tr_b16 a[18:19], v48 offset:39688
    s_waitcnt vmcnt(12) lgkmcnt(10)
    v_mfma_f32_16x16x32_bf16 v[80:83], a[248:251], v[152:155], v[80:83]
    ds_read_b64_tr_b16 a[20:21], v48 offset:38416
    ds_read_b64_tr_b16 a[22:23], v48 offset:39696
    v_mfma_f32_16x16x32_bf16 v[84:87], a[252:255], v[152:155], v[84:87]
    ds_read_b64_tr_b16 a[24:25], v48 offset:38424
    ds_read_b64_tr_b16 a[26:27], v48 offset:39704
    s_waitcnt lgkmcnt(10)
    v_mfma_f32_16x16x32_bf16 v[88:91], a[0:3], v[152:155], v[88:91]
    ds_read_b64_tr_b16 a[28:29], v48 offset:38432
    ds_read_b64_tr_b16 a[30:31], v48 offset:39712
    buffer_load_dwordx4 a[92:95], v55, s[24:27], s1 offen offset:0 sc1
    v_mfma_f32_16x16x32_bf16 v[92:95], a[4:7], v[152:155], v[92:95]
    ds_read_b64_tr_b16 a[32:33], v48 offset:44800
    ds_read_b64_tr_b16 a[34:35], v48 offset:46080
    buffer_load_dword v12, v61, s[24:27], 0 offen offset:256 sc1
    s_waitcnt lgkmcnt(10)
    v_mfma_f32_16x16x32_bf16 v[96:99], a[8:11], v[152:155], v[96:99]
    ds_read_b64_tr_b16 a[36:37], v48 offset:44808
    ds_read_b64_tr_b16 a[38:39], v48 offset:46088
    s_waitcnt vmcnt(13)
    v_mfma_f32_16x16x32_bf16 v[80:83], a[12:15], v[156:159], v[80:83]
    ds_read_b64_tr_b16 a[40:41], v48 offset:44816
    ds_read_b64_tr_b16 a[42:43], v48 offset:46096
    s_waitcnt lgkmcnt(10)
    v_mfma_f32_16x16x32_bf16 v[84:87], a[16:19], v[156:159], v[84:87]
    ds_read_b64_tr_b16 a[44:45], v48 offset:44824
    ds_read_b64_tr_b16 a[46:47], v48 offset:46104
    buffer_load_dwordx4 a[96:99], v55, s[24:27], s1 offen offset:1024 sc1
    v_mfma_f32_16x16x32_bf16 v[88:91], a[20:23], v[156:159], v[88:91]
    ds_read_b64_tr_b16 a[48:49], v48 offset:44832
    ds_read_b64_tr_b16 a[50:51], v48 offset:46112
    s_waitcnt vmcnt(9)
    s_waitcnt lgkmcnt(10)
    v_mfma_f32_16x16x32_bf16 v[92:95], a[24:27], v[156:159], v[92:95]
    ds_read_b64_tr_b16 a[52:53], v49 offset:28160
    ds_read_b64_tr_b16 a[54:55], v49 offset:34560
    buffer_store_dwordx4 v[58:61], v60, s[24:27], 0 offen offset:128 sc1
    v_mfma_f32_16x16x32_bf16 v[96:99], a[28:31], v[156:159], v[96:99]
    ds_read_b64_tr_b16 a[56:57], v49 offset:28168
    ds_read_b64_tr_b16 a[58:59], v49 offset:34568
    s_waitcnt lgkmcnt(10)
    v_mfma_f32_16x16x32_bf16 v[80:83], a[32:35], v[160:163], v[80:83]
    ds_read_b64_tr_b16 a[60:61], v49 offset:28176
    ds_read_b64_tr_b16 a[62:63], v49 offset:34576
    buffer_load_dwordx4 a[100:103], v55, s[24:27], s1 offen offset:2048 sc1
    v_mfma_f32_16x16x32_bf16 v[84:87], a[36:39], v[160:163], v[84:87]
    ds_read_b64_tr_b16 a[64:65], v49 offset:28184
    ds_read_b64_tr_b16 a[66:67], v49 offset:34584
    s_waitcnt lgkmcnt(10)
    v_mfma_f32_16x16x32_bf16 v[88:91], a[40:43], v[160:163], v[88:91]
    ds_read_b64_tr_b16 a[68:69], v49 offset:28192
    ds_read_b64_tr_b16 a[70:71], v49 offset:34592
    v_mfma_f32_16x16x32_bf16 v[92:95], a[44:47], v[160:163], v[92:95]
    s_waitcnt lgkmcnt(8)
    v_mfma_f32_16x16x32_bf16 v[96:99], a[48:51], v[160:163], v[96:99]
    buffer_load_dwordx4 a[104:107], v55, s[24:27], s1 offen offset:3072 sc1
    v_mfma_f32_16x16x32_bf16 v[80:83], a[52:55], v[164:167], v[80:83]
    s_waitcnt lgkmcnt(4)
    v_mfma_f32_16x16x32_bf16 v[84:87], a[56:59], v[164:167], v[84:87]
    v_mfma_f32_16x16x32_bf16 v[88:91], a[60:63], v[164:167], v[88:91]
    s_waitcnt lgkmcnt(0)
    v_mfma_f32_16x16x32_bf16 v[92:95], a[64:67], v[164:167], v[92:95]
    buffer_load_dwordx2 a[108:109], v59, s[24:27], s1 offen offset:0 sc1
    v_mfma_f32_16x16x32_bf16 v[96:99], a[68:71], v[164:167], v[96:99]
    s_waitcnt vmcnt(12)
    v_mfma_f32_16x16x32_bf16 v[100:103], v[216:219], a[72:75], 0
    v_mfma_f32_16x16x32_bf16 v[104:107], v[220:223], a[72:75], 0
    v_mfma_f32_16x16x32_bf16 v[108:111], v[224:227], a[72:75], 0
    buffer_load_dwordx2 a[110:111], v59, s[24:27], s1 offen offset:256 sc1
    v_mfma_f32_16x16x32_bf16 v[112:115], v[228:231], a[72:75], 0
    v_mfma_f32_16x16x32_bf16 v[116:119], v[232:235], a[72:75], 0
    s_waitcnt vmcnt(6)
    v_cmp_ne_u32 vcc, s66, v12
    v_mfma_f32_16x16x32_bf16 v[100:103], v[236:239], a[76:79], v[100:103]
    ds_write_b128 v50, v[80:83] offset:0
    v_mfma_f32_16x16x32_bf16 v[104:107], a[152:155], a[76:79], v[104:107]
    s_cbranch_vccnz L_spin_7
L_ok_8:
    buffer_load_dwordx4 a[112:115], v54, s[24:27], s0 offen offset:0 sc1
    v_mfma_f32_16x16x32_bf16 v[108:111], a[156:159], a[76:79], v[108:111]
    ds_write_b128 v51, v[84:87] offset:0
    v_mfma_f32_16x16x32_bf16 v[112:115], a[160:163], a[76:79], v[112:115]
    ds_write_b128 v50, v[88:91] offset:16
    v_mfma_f32_16x16x32_bf16 v[116:119], a[164:167], a[76:79], v[116:119]
    v_mfma_f32_16x16x32_bf16 v[100:103], a[168:171], a[80:83], v[100:103]
    buffer_load_dwordx4 a[116:119], v54, s[24:27], s0 offen offset:1024 sc1
    ds_write_b128 v51, v[92:95] offset:16
    v_mfma_f32_16x16x32_bf16 v[104:107], a[172:175], a[80:83], v[104:107]
    v_mfma_f32_16x16x32_bf16 v[108:111], a[176:179], a[80:83], v[108:111]
    ds_write_b128 v50, v[96:99] offset:32
    v_mfma_f32_16x16x32_bf16 v[112:115], a[180:183], a[80:83], v[112:115]
    v_mfma_f32_16x16x32_bf16 v[116:119], a[184:187], a[80:83], v[116:119]
    buffer_load_dwordx4 a[120:123], v54, s[24:27], s0 offen offset:2048 sc1
    v_mfma_f32_16x16x32_bf16 v[100:103], a[188:191], a[84:87], v[100:103]
    v_mfma_f32_16x16x32_bf16 v[104:107], a[192:195], a[84:87], v[104:107]
    s_waitcnt lgkmcnt(0)
    v_mfma_f32_16x16x32_bf16 v[108:111], a[196:199], a[84:87], v[108:111]
    s_barrier
    v_mfma_f32_16x16x32_bf16 v[112:115], a[200:203], a[84:87], v[112:115]
    buffer_load_dwordx4 a[124:127], v54, s[24:27], s0 offen offset:3072 sc1
    ds_read_b128 v[64:67], v52 offset:0
    v_mfma_f32_16x16x32_bf16 v[116:119], a[204:207], a[84:87], v[116:119]
    ds_read_b128 v[68:71], v52 offset:11264
    v_mfma_f32_16x16x32_bf16 v[100:103], a[208:211], a[88:91], v[100:103]
    ds_read_b128 v[72:75], v52 offset:5632
    v_mfma_f32_16x16x32_bf16 v[104:107], a[212:215], a[88:91], v[104:107]
    ds_read_b128 v[76:79], v52 offset:16896
    v_mfma_f32_16x16x32_bf16 v[108:111], a[216:219], a[88:91], v[108:111]
    buffer_load_dwordx2 a[128:129], v0, s[24:27], s0 offen offset:0 sc1
    ds_read_b128 v[240:243], v52 offset:704
    v_mfma_f32_16x16x32_bf16 v[112:115], a[220:223], a[88:91], v[112:115]
    ds_read_b128 v[244:247], v52 offset:11968
    v_mfma_f32_16x16x32_bf16 v[116:119], a[224:227], a[88:91], v[116:119]
    ds_read_b128 v[248:251], v52 offset:6336
    v_mfma_f32_16x16x32_bf16 v[100:103], a[228:231], a[92:95], v[100:103]
    ds_read_b128 v[252:255], v52 offset:17600
    v_mfma_f32_16x16x32_bf16 v[104:107], a[232:235], a[92:95], v[104:107]
    buffer_load_dwordx2 a[130:131], v0, s[24:27], s0 offen offset:256 sc1
    s_mov_b32 s56, 245760
    v_mfma_f32_16x16x32_bf16 v[108:111], a[236:239], a[92:95], v[108:111]
    s_waitcnt lgkmcnt(6)
    v_add_f32 v64, v64, v68
    v_mfma_f32_16x16x32_bf16 v[112:115], a[240:243], a[92:95], v[112:115]
    v_add_f32 v65, v65, v69
    v_add_f32 v66, v66, v70
    v_mfma_f32_16x16x32_bf16 v[116:119], a[244:247], a[92:95], v[116:119]
    v_add_f32 v67, v67, v71
    s_waitcnt vmcnt(11)
    v_mfma_f32_16x16x32_bf16 v[100:103], a[248:251], a[96:99], v[100:103]
    v_cvt_pk_bf16_f32 v64, v64, v65
    buffer_load_dwordx4 a[132:135], v55, s[24:27], s0 offen offset:0 sc1
    v_mfma_f32_16x16x32_bf16 v[104:107], a[252:255], a[96:99], v[104:107]
    v_cvt_pk_bf16_f32 v65, v66, v67
    s_waitcnt lgkmcnt(4)
    v_mfma_f32_16x16x32_bf16 v[108:111], a[0:3], a[96:99], v[108:111]
    v_add_f32 v72, v72, v76
    buffer_load_dword v13, v61, s[24:27], 0 offen offset:128 sc1
    v_mfma_f32_16x16x32_bf16 v[112:115], a[4:7], a[96:99], v[112:115]
    v_add_f32 v73, v73, v77
    v_add_f32 v74, v74, v78
    v_mfma_f32_16x16x32_bf16 v[116:119], a[8:11], a[96:99], v[116:119]
    v_add_f32 v75, v75, v79
    s_waitcnt vmcnt(11)
    v_mfma_f32_16x16x32_bf16 v[100:103], a[12:15], a[100:103], v[100:103]
    buffer_load_dwordx4 a[136:139], v55, s[24:27], s0 offen offset:1024 sc1
    v_cvt_pk_bf16_f32 v66, v72, v73
    v_mfma_f32_16x16x32_bf16 v[104:107], a[16:19], a[100:103], v[104:107]
    v_cvt_pk_bf16_f32 v67, v74, v75
    buffer_store_dwordx4 v[64:67], v56, s[20:23], s56 offen nt
    v_mfma_f32_16x16x32_bf16 v[108:111], a[20:23], a[100:103], v[108:111]
    s_mov_b32 s56, 256000
    s_waitcnt lgkmcnt(2)
    v_mfma_f32_16x16x32_bf16 v[112:115], a[24:27], a[100:103], v[112:115]
    v_add_f32 v240, v240, v244
    buffer_load_dwordx4 a[140:143], v55, s[24:27], s0 offen offset:2048 sc1
    v_mfma_f32_16x16x32_bf16 v[116:119], a[28:31], a[100:103], v[116:119]
    v_add_f32 v241, v241, v245
    s_waitcnt vmcnt(13)
    v_mfma_f32_16x16x32_bf16 v[100:103], a[32:35], a[104:107], v[100:103]
    v_add_f32 v242, v242, v246
    v_add_f32 v243, v243, v247
    v_mfma_f32_16x16x32_bf16 v[104:107], a[36:39], a[104:107], v[104:107]
    v_cvt_pk_bf16_f32 v240, v240, v241
    v_cvt_pk_bf16_f32 v241, v242, v243
    v_mfma_f32_16x16x32_bf16 v[108:111], a[40:43], a[104:107], v[108:111]
    s_waitcnt lgkmcnt(0)
    buffer_load_dwordx4 a[144:147], v55, s[24:27], s0 offen offset:3072 sc1
    v_mfma_f32_16x16x32_bf16 v[112:115], a[44:47], a[104:107], v[112:115]
    v_add_f32 v248, v248, v252
    v_add_f32_e64 v249, v249, v253
    v_mfma_f32_16x16x32_bf16 v[116:119], a[48:51], a[104:107], v[116:119]
    v_add_f32 v250, v250, v254
    s_waitcnt vmcnt(12)
    v_mfma_f32_16x16x32_bf16 v[100:103], a[52:55], a[108:111], v[100:103]
    v_add_f32_e64 v251, v251, v255
    v_cvt_pk_bf16_f32 v242, v248, v249
    v_mfma_f32_16x16x32_bf16 v[104:107], a[56:59], a[108:111], v[104:107]
    v_cvt_pk_bf16_f32 v243, v250, v251
    buffer_load_dwordx2 a[148:149], v59, s[24:27], s0 offen offset:0 sc1
    v_mfma_f32_16x16x32_bf16 v[108:111], a[60:63], a[108:111], v[108:111]
    buffer_store_dwordx4 v[240:243], v56, s[20:23], s56 offen nt
    v_mfma_f32_16x16x32_bf16 v[112:115], a[64:67], a[108:111], v[112:115]
    v_mfma_f32_16x16x32_bf16 v[116:119], a[68:71], a[108:111], v[116:119]
    s_waitcnt vmcnt(13)
    v_mfma_f32_16x16x32_bf16 v[80:83], v[216:219], a[112:115], 0
    buffer_load_dwordx2 a[150:151], v59, s[24:27], s0 offen offset:256 sc1
    v_mfma_f32_16x16x32_bf16 v[84:87], v[220:223], a[112:115], 0
    v_mfma_f32_16x16x32_bf16 v[88:91], v[224:227], a[112:115], 0
    v_mfma_f32_16x16x32_bf16 v[92:95], v[228:231], a[112:115], 0
    v_mfma_f32_16x16x32_bf16 v[96:99], v[232:235], a[112:115], 0
    ds_write_b128 v50, v[100:103] offset:22528
    s_waitcnt vmcnt(13)
    v_mfma_f32_16x16x32_bf16 v[80:83], v[236:239], a[116:119], v[80:83]
    v_mfma_f32_16x16x32_bf16 v[84:87], a[152:155], a[116:119], v[84:87]
    ds_write_b128 v51, v[104:107] offset:22528
    v_mfma_f32_16x16x32_bf16 v[88:91], a[156:159], a[116:119], v[88:91]
    v_mfma_f32_16x16x32_bf16 v[92:95], a[160:163], a[116:119], v[92:95]
    s_waitcnt vmcnt(7)
    v_cmp_ne_u32 vcc, s66, v13
    ds_write_b128 v50, v[108:111] offset:22544
    v_mfma_f32_16x16x32_bf16 v[96:99], a[164:167], a[116:119], v[96:99]
    v_mfma_f32_16x16x32_bf16 v[80:83], a[168:171], a[120:123], v[80:83]
    s_cbranch_vccnz L_spin_9
L_ok_10:
    buffer_load_dwordx4 v[176:179], v54, s[24:27], 0 offen offset:0 sc1
    v_mfma_f32_16x16x32_bf16 v[84:87], a[172:175], a[120:123], v[84:87]
    ds_write_b128 v51, v[112:115] offset:22544
    v_mfma_f32_16x16x32_bf16 v[88:91], a[176:179], a[120:123], v[88:91]
    ds_write_b128 v50, v[116:119] offset:22560
    v_mfma_f32_16x16x32_bf16 v[92:95], a[180:183], a[120:123], v[92:95]
    v_mfma_f32_16x16x32_bf16 v[96:99], a[184:187], a[120:123], v[96:99]
    buffer_load_dwordx4 v[180:183], v54, s[24:27], 0 offen offset:1024 sc1
    v_mfma_f32_16x16x32_bf16 v[80:83], a[188:191], a[124:127], v[80:83]
    v_mfma_f32_16x16x32_bf16 v[84:87], a[192:195], a[124:127], v[84:87]
    s_waitcnt lgkmcnt(0)
    v_mfma_f32_16x16x32_bf16 v[88:91], a[196:199], a[124:127], v[88:91]
    s_barrier
    v_mfma_f32_16x16x32_bf16 v[92:95], a[200:203], a[124:127], v[92:95]
    buffer_load_dwordx4 v[184:187], v54, s[24:27], 0 offen offset:2048 sc1
    ds_read_b128 v[64:67], v52 offset:22528
    v_mfma_f32_16x16x32_bf16 v[96:99], a[204:207], a[124:127], v[96:99]
    ds_read_b128 v[68:71], v52 offset:33792
    v_mfma_f32_16x16x32_bf16 v[80:83], a[208:211], a[128:131], v[80:83]
    ds_read_b128 v[72:75], v52 offset:28160
    v_mfma_f32_16x16x32_bf16 v[84:87], a[212:215], a[128:131], v[84:87]
    ds_read_b128 v[76:79], v52 offset:39424
    v_mfma_f32_16x16x32_bf16 v[88:91], a[216:219], a[128:131], v[88:91]
    buffer_load_dwordx4 v[188:191], v54, s[24:27], 0 offen offset:3072 sc1
    ds_read_b128 v[240:243], v52 offset:23232
    v_mfma_f32_16x16x32_bf16 v[92:95], a[220:223], a[128:131], v[92:95]
    ds_read_b128 v[244:247], v52 offset:34496
    v_mfma_f32_16x16x32_bf16 v[96:99], a[224:227], a[128:131], v[96:99]
    ds_read_b128 v[248:251], v52 offset:28864
    v_mfma_f32_16x16x32_bf16 v[80:83], a[228:231], a[132:135], v[80:83]
    ds_read_b128 v[252:255], v52 offset:40128
    v_mfma_f32_16x16x32_bf16 v[84:87], a[232:235], a[132:135], v[84:87]
    buffer_load_dwordx2 v[192:193], v0, s[24:27], 0 offen offset:0 sc1
    s_mov_b32 s56, 163840
    v_mfma_f32_16x16x32_bf16 v[88:91], a[236:239], a[132:135], v[88:91]
    s_waitcnt lgkmcnt(6)
    v_add_f32_e64 v64, v64, v68
    v_mfma_f32_16x16x32_bf16 v[92:95], a[240:243], a[132:135], v[92:95]
    v_add_f32 v65, v65, v69
    v_add_f32 v66, v66, v70
    v_mfma_f32_16x16x32_bf16 v[96:99], a[244:247], a[132:135], v[96:99]
    v_add_f32 v67, v67, v71
    s_waitcnt vmcnt(11)
    v_mfma_f32_16x16x32_bf16 v[80:83], a[248:251], a[136:139], v[80:83]
    v_cvt_pk_bf16_f32 v64, v64, v65
    buffer_load_dwordx2 v[194:195], v0, s[24:27], 0 offen offset:256 sc1
    v_mfma_f32_16x16x32_bf16 v[84:87], a[252:255], a[136:139], v[84:87]
    v_cvt_pk_bf16_f32 v65, v66, v67
    s_waitcnt lgkmcnt(4)
    v_mfma_f32_16x16x32_bf16 v[88:91], a[0:3], a[136:139], v[88:91]
    v_add_f32 v72, v72, v76
    v_add_f32_e64 v73, v73, v77
    v_mfma_f32_16x16x32_bf16 v[92:95], a[4:7], a[136:139], v[92:95]
    v_add_f32 v74, v74, v78
    v_add_f32 v75, v75, v79
    v_mfma_f32_16x16x32_bf16 v[96:99], a[8:11], a[136:139], v[96:99]
    buffer_load_dwordx4 v[196:199], v55, s[24:27], 0 offen offset:0 sc1
    s_waitcnt vmcnt(11)
    v_mfma_f32_16x16x32_bf16 v[80:83], a[12:15], a[140:143], v[80:83]
    v_cvt_pk_bf16_f32 v66, v72, v73
    v_cvt_pk_bf16_f32 v67, v74, v75
    v_mfma_f32_16x16x32_bf16 v[84:87], a[16:19], a[140:143], v[84:87]
    buffer_store_dwordx4 v[64:67], v56, s[20:23], s56 offen nt
    s_mov_b32 s56, 174080
    v_mfma_f32_16x16x32_bf16 v[88:91], a[20:23], a[140:143], v[88:91]
    s_waitcnt lgkmcnt(2)
    v_add_f32_e64 v240, v240, v244
    v_mfma_f32_16x16x32_bf16 v[92:95], a[24:27], a[140:143], v[92:95]
    buffer_load_dwordx4 v[200:203], v55, s[24:27], 0 offen offset:1024 sc1
    v_add_f32_e64 v241, v241, v245
    v_mfma_f32_16x16x32_bf16 v[96:99], a[28:31], a[140:143], v[96:99]
    v_add_f32 v242, v242, v246
    s_waitcnt vmcnt(12)
    v_mfma_f32_16x16x32_bf16 v[80:83], a[32:35], a[144:147], v[80:83]
    v_add_f32_e64 v243, v243, v247
    v_cvt_pk_bf16_f32 v240, v240, v241
    v_mfma_f32_16x16x32_bf16 v[84:87], a[36:39], a[144:147], v[84:87]
    v_cvt_pk_bf16_f32 v241, v242, v243
    s_waitcnt lgkmcnt(0)
    v_mfma_f32_16x16x32_bf16 v[88:91], a[40:43], a[144:147], v[88:91]
    buffer_load_dwordx4 v[204:207], v55, s[24:27], 0 offen offset:2048 sc1
    v_add_f32 v248, v248, v252
    v_mfma_f32_16x16x32_bf16 v[92:95], a[44:47], a[144:147], v[92:95]
    v_add_f32 v249, v249, v253
    v_add_f32 v250, v250, v254
    v_mfma_f32_16x16x32_bf16 v[96:99], a[48:51], a[144:147], v[96:99]
    v_add_f32 v251, v251, v255
    s_waitcnt vmcnt(10)
    v_mfma_f32_16x16x32_bf16 v[80:83], a[52:55], a[148:151], v[80:83]
    v_cvt_pk_bf16_f32 v242, v248, v249
    v_cvt_pk_bf16_f32 v243, v250, v251
    v_mfma_f32_16x16x32_bf16 v[84:87], a[56:59], a[148:151], v[84:87]
    buffer_load_dwordx4 v[208:211], v55, s[24:27], 0 offen offset:3072 sc1
    buffer_store_dwordx4 v[240:243], v56, s[20:23], s56 offen nt
    v_mfma_f32_16x16x32_bf16 v[88:91], a[60:63], a[148:151], v[88:91]
    v_mfma_f32_16x16x32_bf16 v[92:95], a[64:67], a[148:151], v[92:95]
    v_mfma_f32_16x16x32_bf16 v[96:99], a[68:71], a[148:151], v[96:99]
    s_waitcnt vmcnt(11)
    v_mfma_f32_16x16x32_bf16 v[100:103], v[216:219], v[176:179], 0
    buffer_load_dwordx2 v[212:213], v59, s[24:27], 0 offen offset:0 sc1
    v_mfma_f32_16x16x32_bf16 v[104:107], v[220:223], v[176:179], 0
    v_mfma_f32_16x16x32_bf16 v[108:111], v[224:227], v[176:179], 0
    v_mfma_f32_16x16x32_bf16 v[112:115], v[228:231], v[176:179], 0
    v_mfma_f32_16x16x32_bf16 v[116:119], v[232:235], v[176:179], 0
    buffer_load_dwordx2 v[214:215], v59, s[24:27], 0 offen offset:256 sc1
    s_waitcnt vmcnt(12)
    v_mfma_f32_16x16x32_bf16 v[100:103], v[236:239], v[180:183], v[100:103]
    ds_write_b128 v50, v[80:83] offset:0
    v_mfma_f32_16x16x32_bf16 v[104:107], a[152:155], v[180:183], v[104:107]
    ds_write_b128 v51, v[84:87] offset:0
    v_mfma_f32_16x16x32_bf16 v[108:111], a[156:159], v[180:183], v[108:111]
    v_mfma_f32_16x16x32_bf16 v[112:115], a[160:163], v[180:183], v[112:115]
    ds_write_b128 v50, v[88:91] offset:16
    v_mfma_f32_16x16x32_bf16 v[116:119], a[164:167], v[180:183], v[116:119]
    s_waitcnt vmcnt(11)
    v_mfma_f32_16x16x32_bf16 v[100:103], a[168:171], v[184:187], v[100:103]
    ds_write_b128 v51, v[92:95] offset:16
    v_mfma_f32_16x16x32_bf16 v[104:107], a[172:175], v[184:187], v[104:107]
    v_mfma_f32_16x16x32_bf16 v[108:111], a[176:179], v[184:187], v[108:111]
    ds_write_b128 v50, v[96:99] offset:32
    v_mfma_f32_16x16x32_bf16 v[112:115], a[180:183], v[184:187], v[112:115]
    v_mfma_f32_16x16x32_bf16 v[116:119], a[184:187], v[184:187], v[116:119]
    s_waitcnt vmcnt(10)
    v_mfma_f32_16x16x32_bf16 v[100:103], a[188:191], v[188:191], v[100:103]
    v_mfma_f32_16x16x32_bf16 v[104:107], a[192:195], v[188:191], v[104:107]
    s_waitcnt lgkmcnt(0)
    v_mfma_f32_16x16x32_bf16 v[108:111], a[196:199], v[188:191], v[108:111]
    s_barrier
    v_mfma_f32_16x16x32_bf16 v[112:115], a[200:203], v[188:191], v[112:115]
    ds_read_b128 v[64:67], v52 offset:0
    v_mfma_f32_16x16x32_bf16 v[116:119], a[204:207], v[188:191], v[116:119]
    ds_read_b128 v[68:71], v52 offset:11264
    s_waitcnt vmcnt(8)
    v_mfma_f32_16x16x32_bf16 v[100:103], a[208:211], v[192:195], v[100:103]
    ds_read_b128 v[72:75], v52 offset:5632
    v_mfma_f32_16x16x32_bf16 v[104:107], a[212:215], v[192:195], v[104:107]
    ds_read_b128 v[76:79], v52 offset:16896
    v_mfma_f32_16x16x32_bf16 v[108:111], a[216:219], v[192:195], v[108:111]
    ds_read_b128 v[240:243], v52 offset:704
    v_mfma_f32_16x16x32_bf16 v[112:115], a[220:223], v[192:195], v[112:115]
    ds_read_b128 v[244:247], v52 offset:11968
    v_mfma_f32_16x16x32_bf16 v[116:119], a[224:227], v[192:195], v[116:119]
    ds_read_b128 v[248:251], v52 offset:6336
    s_waitcnt vmcnt(7)
    v_mfma_f32_16x16x32_bf16 v[100:103], a[228:231], v[196:199], v[100:103]
    ds_read_b128 v[252:255], v52 offset:17600
    v_mfma_f32_16x16x32_bf16 v[104:107], a[232:235], v[196:199], v[104:107]
    s_mov_b32 s56, 81920
    s_waitcnt lgkmcnt(6)
    v_mfma_f32_16x16x32_bf16 v[108:111], a[236:239], v[196:199], v[108:111]
    v_add_f32 v64, v64, v68
    v_add_f32_e64 v65, v65, v69
    v_mfma_f32_16x16x32_bf16 v[112:115], a[240:243], v[196:199], v[112:115]
    v_add_f32_e64 v66, v66, v70
    v_mfma_f32_16x16x32_bf16 v[116:119], a[244:247], v[196:199], v[116:119]
    v_add_f32 v67, v67, v71
    s_waitcnt vmcnt(5)
    v_mfma_f32_16x16x32_bf16 v[100:103], a[248:251], v[200:203], v[100:103]
    v_cvt_pk_bf16_f32 v64, v64, v65
    v_cvt_pk_bf16_f32 v65, v66, v67
    s_waitcnt vmcnt(4)
    v_mfma_f32_16x16x32_bf16 v[100:103], a[12:15], v[204:207], v[100:103]
    s_waitcnt lgkmcnt(4)
    v_add_f32 v72, v72, v76
    s_waitcnt vmcnt(3)
    v_mfma_f32_16x16x32_bf16 v[100:103], a[32:35], v[208:211], v[100:103]
    v_add_f32 v73, v73, v77
    s_waitcnt vmcnt(0)
    v_mfma_f32_16x16x32_bf16 v[100:103], a[52:55], v[212:215], v[100:103]
    v_add_f32 v74, v74, v78
    v_add_f32 v75, v75, v79
    v_mfma_f32_16x16x32_bf16 v[104:107], a[252:255], v[200:203], v[104:107]
    v_cvt_pk_bf16_f32 v66, v72, v73
    v_mfma_f32_16x16x32_bf16 v[104:107], a[16:19], v[204:207], v[104:107]
    v_cvt_pk_bf16_f32 v67, v74, v75
    buffer_store_dwordx4 v[64:67], v56, s[20:23], s56 offen nt
    v_mfma_f32_16x16x32_bf16 v[104:107], a[36:39], v[208:211], v[104:107]
    s_mov_b32 s56, 92160
    v_mfma_f32_16x16x32_bf16 v[104:107], a[56:59], v[212:215], v[104:107]
    s_waitcnt lgkmcnt(2)
    v_add_f32 v240, v240, v244
    v_mfma_f32_16x16x32_bf16 v[108:111], a[0:3], v[200:203], v[108:111]
    v_add_f32_e64 v241, v241, v245
    v_mfma_f32_16x16x32_bf16 v[108:111], a[20:23], v[204:207], v[108:111]
    v_add_f32 v242, v242, v246
    v_add_f32 v243, v243, v247
    v_mfma_f32_16x16x32_bf16 v[108:111], a[40:43], v[208:211], v[108:111]
    v_cvt_pk_bf16_f32 v240, v240, v241
    v_mfma_f32_16x16x32_bf16 v[108:111], a[60:63], v[212:215], v[108:111]
    ds_write_b128 v50, v[100:103] offset:22528
    v_cvt_pk_bf16_f32 v241, v242, v243
    v_mfma_f32_16x16x32_bf16 v[112:115], a[4:7], v[200:203], v[112:115]
    s_waitcnt lgkmcnt(1)
    v_add_f32 v248, v248, v252
    v_mfma_f32_16x16x32_bf16 v[112:115], a[24:27], v[204:207], v[112:115]
    v_add_f32 v249, v249, v253
    v_add_f32 v250, v250, v254
    v_mfma_f32_16x16x32_bf16 v[112:115], a[44:47], v[208:211], v[112:115]
    v_add_f32_e64 v251, v251, v255
    v_mfma_f32_16x16x32_bf16 v[112:115], a[64:67], v[212:215], v[112:115]
    ds_write_b128 v51, v[104:107] offset:22528
    v_cvt_pk_bf16_f32 v242, v248, v249
    v_mfma_f32_16x16x32_bf16 v[116:119], a[8:11], v[200:203], v[116:119]
    v_cvt_pk_bf16_f32 v243, v250, v251
    v_mfma_f32_16x16x32_bf16 v[116:119], a[28:31], v[204:207], v[116:119]
    buffer_store_dwordx4 v[240:243], v56, s[20:23], s56 offen nt
    v_mfma_f32_16x16x32_bf16 v[116:119], a[48:51], v[208:211], v[116:119]
    v_mfma_f32_16x16x32_bf16 v[116:119], a[68:71], v[212:215], v[116:119]
    ds_write_b128 v50, v[108:111] offset:22544
    s_nop 3
    ds_write_b128 v51, v[112:115] offset:22544
    s_nop 2
    ds_write_b128 v50, v[116:119] offset:22560
L_redone:
    s_waitcnt lgkmcnt(0)
    s_barrier
    ds_read_b128 v[64:67], v52 offset:22528
    ds_read_b128 v[68:71], v52 offset:33792
    ds_read_b128 v[72:75], v52 offset:28160
    ds_read_b128 v[76:79], v52 offset:39424
    ds_read_b128 v[240:243], v52 offset:23232
    ds_read_b128 v[244:247], v52 offset:34496
    ds_read_b128 v[248:251], v52 offset:28864
    ds_read_b128 v[252:255], v52 offset:40128
    s_mov_b32 s56, 0
    s_waitcnt lgkmcnt(6)
    v_pk_add_f32 v[64:65], v[64:65], v[68:69]
    v_pk_add_f32 v[66:67], v[66:67], v[70:71]
    v_cvt_pk_bf16_f32 v64, v64, v65
    v_cvt_pk_bf16_f32 v65, v66, v67
    s_waitcnt lgkmcnt(4)
    v_pk_add_f32 v[72:73], v[72:73], v[76:77]
    v_pk_add_f32 v[74:75], v[74:75], v[78:79]
    v_cvt_pk_bf16_f32 v66, v72, v73
    v_cvt_pk_bf16_f32 v67, v74, v75
    buffer_store_dwordx4 v[64:67], v56, s[20:23], s56 offen nt
    s_mov_b32 s56, 10240
    s_waitcnt lgkmcnt(2)
    v_pk_add_f32 v[240:241], v[240:241], v[244:245]
    v_pk_add_f32 v[242:243], v[242:243], v[246:247]
    v_cvt_pk_bf16_f32 v240, v240, v241
    v_cvt_pk_bf16_f32 v241, v242, v243
    s_waitcnt lgkmcnt(0)
    v_pk_add_f32 v[248:249], v[248:249], v[252:253]
    v_pk_add_f32 v[250:251], v[250:251], v[254:255]
    v_cvt_pk_bf16_f32 v242, v248, v249
    v_cvt_pk_bf16_f32 v243, v250, v251
    buffer_store_dwordx4 v[240:243], v56, s[20:23], s56 offen nt
    s_endpgm
L_slow:
    s_waitcnt vmcnt(0) lgkmcnt(0)
    s_nop 15
    s_mov_b32 s43, s48
    v_mov_b32 v232, 0x3F803F80
    v_mov_b32 v233, 0x3F803F80
    v_mov_b32 v234, 0x3F803F80
    v_mov_b32 v235, 0x3F803F80
    v_mov_b32 v236, 0x3F803F80
    v_mov_b32 v237, 0x3F803F80
    v_mov_b32 v238, 0x3F803F80
    v_mov_b32 v239, 0x3F803F80
    v_mov_b32 v220, 0
    v_mov_b32 v221, 0
    v_and_b32 v6, 31, v1
    v_lshrrev_b32 v7, 5, v1
    v_lshlrev_b32 v7, 2, v7
    v_sub_u32 v6, v6, v7
    s_mul_i32 s56, s54, 2560
    s_add_u32 s56, s56, 25165824
    v_lshrrev_b32 v2, 4, v1
    v_mul_u32_u24 v2, 640, v2
    v_add_u32 v2, s56, v2
    buffer_load_dword v10, v2, s[24:27], 0 offen offset:0 sc1
    s_waitcnt vmcnt(0)
    v_cmp_ne_u32 vcc, s66, v10
    s_cbranch_vccnz L_spin_11
L_ok_12:
L_slow_q:
    s_mul_i32 s56, s48, 1280
    v_add_u32 v2, s56, v57
    v_add_u32 v3, s56, v38
    ds_read_b128 v[216:219], v2
    s_mov_b32 exec_hi, 0
    ds_read_b64 v[220:221], v3
    s_mov_b32 exec_hi, -1
    s_lshl_b32 s56, s33, 2
    s_add_u32 s56, s56, s48
    s_sub_i32 s50, 8, s56
    s_max_i32 s50, s50, 0
    v_mov_b32 v222, 0xff800000
    v_mov_b32 v64, 0
    v_mov_b32 v65, 0
    v_mov_b32 v66, 0
    v_mov_b32 v67, 0
    v_mov_b32 v68, 0
    v_mov_b32 v69, 0
    v_mov_b32 v70, 0
    v_mov_b32 v71, 0
    v_mov_b32 v72, 0
    v_mov_b32 v73, 0
    v_mov_b32 v74, 0
    v_mov_b32 v75, 0
    v_mov_b32 v76, 0
    v_mov_b32 v77, 0
    v_mov_b32 v78, 0
    v_mov_b32 v79, 0
    s_mov_b32 s52, 0
L_slow_pass:
    s_mov_b32 s49, s50
L_slow_k:
    s_add_u32 s56, s48, s49
    s_lshr_b32 s57, s56, 2
    s_and_b32 s56, s56, 3
    s_mul_i32 s57, s57, 327680
    s_mul_i32 s56, s56, 1280
    s_add_u32 s51, s56, s57
    s_add_u32 s51, s51, s69
    s_sub_u32 s51, s51, 655360
    s_add_u32 s57, s51, 20480
    buffer_load_dwordx4 v[224:227], v35, s[24:27], s51 offen sc1
    buffer_load_dwordx2 v[228:229], v36, s[24:27], s51 offen sc1
    s_mov_b64 exec, s[44:45]
    buffer_load_dwordx4 v[232:235], v37, s[24:27], s57 offen sc1
    buffer_load_dwordx4 v[236:239], v37, s[24:27], s57 offen offset:640 sc1
    s_mov_b64 exec, -1
    s_waitcnt vmcnt(0) lgkmcnt(0)
    v_mfma_f32_32x32x16_bf16 v[128:143], v[224:227], v[216:219], 0
    v_mfma_f32_32x32x8_bf16 v[128:143], v[228:229], v[220:221], v[128:143]
    s_sub_u32 s56, 8, s49
    s_lshl_b32 s56, s56, 5
    v_add_u32 v7, s56, v6
    v_mov_b32 v8, 0xff800000
    s_movk_i32 s57, 256
    s_nop 9
    v_subrev_u32 v9, 0, v7
    v_cmp_gt_u32 vcc, s57, v9
    s_nop 1
    v_cndmask_b32 v128, v8, v128, vcc
    v_subrev_u32 v9, 1, v7
    v_cmp_gt_u32 vcc, s57, v9
    s_nop 1
    v_cndmask_b32 v129, v8, v129, vcc
    v_subrev_u32 v9, 2, v7
    v_cmp_gt_u32 vcc, s57, v9
    s_nop 1
    v_cndmask_b32 v130, v8, v130, vcc
    v_subrev_u32 v9, 3, v7
    v_cmp_gt_u32 vcc, s57, v9
    s_nop 1
    v_cndmask_b32 v131, v8, v131, vcc
    v_subrev_u32 v9, 16, v7
    v_cmp_gt_u32 vcc, s57, v9
    s_nop 1
    v_cndmask_b32 v132, v8, v132, vcc
    v_subrev_u32 v9, 17, v7
    v_cmp_gt_u32 vcc, s57, v9
    s_nop 1
    v_cndmask_b32 v133, v8, v133, vcc
    v_subrev_u32 v9, 18, v7
    v_cmp_gt_u32 vcc, s57, v9
    s_nop 1
    v_cndmask_b32 v134, v8, v134, vcc
    v_subrev_u32 v9, 19, v7
    v_cmp_gt_u32 vcc, s57, v9
    s_nop 1
    v_cndmask_b32 v135, v8, v135, vcc
    v_subrev_u32 v9, 8, v7
    v_cmp_gt_u32 vcc, s57, v9
    s_nop 1
    v_cndmask_b32 v136, v8, v136, vcc
    v_subrev_u32 v9, 9, v7
    v_cmp_gt_u32 vcc, s57, v9
    s_nop 1
    v_cndmask_b32 v137, v8, v137, vcc
    v_subrev_u32 v9, 10, v7
    v_cmp_gt_u32 vcc, s57, v9
    s_nop 1
    v_cndmask_b32 v138, v8, v138, vcc
    v_subrev_u32 v9, 11, v7
    v_cmp_gt_u32 vcc, s57, v9
    s_nop 1
    v_cndmask_b32 v139, v8, v139, vcc
    v_subrev_u32 v9, 24, v7
    v_cmp_gt_u32 vcc, s57, v9
    s_nop 1
    v_cndmask_b32 v140, v8, v140, vcc
    v_subrev_u32 v9, 25, v7
    v_cmp_gt_u32 vcc, s57, v9
    s_nop 1
    v_cndmask_b32 v141, v8, v141, vcc
    v_subrev_u32 v9, 26, v7
    v_cmp_gt_u32 vcc, s57, v9
    s_nop 1
    v_cndmask_b32 v142, v8, v142, vcc
    v_subrev_u32 v9, 27, v7
    v_cmp_gt_u32 vcc, s57, v9
    s_nop 1
    v_cndmask_b32 v143, v8, v143, vcc
    s_cmp_eq_u32 s52, 0
    s_cbranch_scc0 L_slow_p2
    v_max_f32 v222, v222, v128
    v_max_f32 v222, v222, v129
    v_max_f32 v222, v222, v130
    v_max_f32 v222, v222, v131
    v_max_f32 v222, v222, v132
    v_max_f32 v222, v222, v133
    v_max_f32 v222, v222, v134
    v_max_f32 v222, v222, v135
    v_max_f32 v222, v222, v136
    v_max_f32 v222, v222, v137
    v_max_f32 v222, v222, v138
    v_max_f32 v222, v222, v139
    v_max_f32 v222, v222, v140
    v_max_f32 v222, v222, v141
    v_max_f32 v222, v222, v142
    v_max_f32 v222, v222, v143
    s_branch L_slow_next
L_slow_p2:
    v_sub_f32 v128, v128, v222
    v_sub_f32 v129, v129, v222
    v_sub_f32 v130, v130, v222
    v_sub_f32 v131, v131, v222
    v_sub_f32 v132, v132, v222
    v_sub_f32 v133, v133, v222
    v_sub_f32 v134, v134, v222
    v_sub_f32 v135, v135, v222
    v_sub_f32 v136, v136, v222
    v_sub_f32 v137, v137, v222
    v_sub_f32 v138, v138, v222
    v_sub_f32 v139, v139, v222
    v_sub_f32 v140, v140, v222
    v_sub_f32 v141, v141, v222
    v_sub_f32 v142, v142, v222
    v_sub_f32 v143, v143, v222
    v_exp_f32 v128, v128
    v_exp_f32 v129, v129
    v_exp_f32 v130, v130
    v_exp_f32 v131, v131
    v_exp_f32 v132, v132
    v_exp_f32 v133, v133
    v_exp_f32 v134, v134
    v_exp_f32 v135, v135
    v_exp_f32 v136, v136
    v_exp_f32 v137, v137
    v_exp_f32 v138, v138
    v_exp_f32 v139, v139
    v_exp_f32 v140, v140
    v_exp_f32 v141, v141
    v_exp_f32 v142, v142
    v_exp_f32_e64 v143, v143
    s_nop 0
    v_cvt_pk_bf16_f32 v208, v128, v129
    v_cvt_pk_bf16_f32 v209, v130, v131
    v_cvt_pk_bf16_f32 v210, v132, v133
    v_cvt_pk_bf16_f32 v211, v134, v135
    v_cvt_pk_bf16_f32 v212, v136, v137
    v_cvt_pk_bf16_f32 v213, v138, v139
    v_cvt_pk_bf16_f32 v214, v140, v141
    v_cvt_pk_bf16_f32 v215, v142, v143
    s_nop 1
    v_mfma_f32_32x32x16_bf16 v[64:79], v[232:235], v[208:211], v[64:79]
    v_mfma_f32_32x32x16_bf16 v[64:79], v[236:239], v[212:215], v[64:79]
    s_nop 15
L_slow_next:
    s_add_u32 s49, s49, 1
    s_cmp_le_u32 s49, 8
    s_cbranch_scc1 L_slow_k
    s_cmp_eq_u32 s52, 0
    s_cbranch_scc0 L_slow_fin
    v_mov_b32 v9, v222
    s_nop 1
    v_permlane32_swap_b32 v9, v222
    s_nop 1
    v_max_f32 v222, v222, v9
    s_mov_b32 s52, 1
    s_branch L_slow_pass
L_slow_fin:
    v_rcp_f32 v168, v76
    s_mul_i32 s56, s48, 40960
    v_pk_mul_f32 v[64:65], v[64:65], v[168:169] op_sel_hi:[1,0]
    v_pk_mul_f32 v[66:67], v[66:67], v[168:169] op_sel_hi:[1,0]
    v_pk_mul_f32 v[68:69], v[68:69], v[168:169] op_sel_hi:[1,0]
    v_pk_mul_f32 v[70:71], v[70:71], v[168:169] op_sel_hi:[1,0]
    v_pk_mul_f32 v[72:73], v[72:73], v[168:169] op_sel_hi:[1,0]
    v_pk_mul_f32 v[74:75], v[74:75], v[168:169] op_sel_hi:[1,0]
    v_cvt_pk_bf16_f32 v64, v64, v65
    v_cvt_pk_bf16_f32 v65, v66, v67
    v_cvt_pk_bf16_f32 v66, v68, v69
    v_cvt_pk_bf16_f32 v67, v70, v71
    v_cvt_pk_bf16_f32 v68, v72, v73
    v_cvt_pk_bf16_f32 v69, v74, v75
    buffer_store_dwordx4 v[64:67], v46, s[24:27], s56 offen sc1
    buffer_store_dwordx2 v[68:69], v47, s[24:27], s56 offen sc1
    s_waitcnt vmcnt(0)
    s_sub_u32 s48, s48, 1
    s_cbranch_scc0 L_slow_q
    buffer_store_dwordx4 v[58:61], v60, s[24:27], 0 offen offset:384 sc1
    buffer_store_dwordx4 v[58:61], v60, s[24:27], 0 offen offset:256 sc1
    s_cmp_eq_u32 s43, 0
    s_cbranch_scc1 L_slow_wo
    s_add_u32 m0, s63, 0
    s_nop 0
    buffer_load_dwordx4 v19, s[16:19], s4 offen offset:0 lds
    buffer_load_dwordx4 v20, s[16:19], s4 offen offset:1024 lds
    buffer_load_dwordx4 v21, s[16:19], s4 offen offset:2048 lds
    buffer_load_dwordx4 v22, s[16:19], s4 offen offset:3072 lds
    s_add_u32 m0, s63, 4096
    s_nop 0
    buffer_load_dwordx4 v23, s[16:19], s4 offen lds
    s_add_u32 m0, s63, 20480
    s_nop 0
    buffer_load_dwordx4 v19, s[16:19], s5 offen offset:0 lds
    buffer_load_dwordx4 v20, s[16:19], s5 offen offset:1024 lds
    buffer_load_dwordx4 v21, s[16:19], s5 offen offset:2048 lds
    buffer_load_dwordx4 v22, s[16:19], s5 offen offset:3072 lds
    s_add_u32 m0, s63, 24576
    s_nop 0
    buffer_load_dwordx4 v23, s[16:19], s5 offen lds
    s_add_u32 m0, s63, 40960
    s_nop 0
    buffer_load_dwordx4 v19, s[16:19], s100 offen offset:0 lds
    buffer_load_dwordx4 v20, s[16:19], s100 offen offset:1024 lds
    buffer_load_dwordx4 v21, s[16:19], s100 offen offset:2048 lds
    buffer_load_dwordx4 v22, s[16:19], s100 offen offset:3072 lds
    s_add_u32 m0, s63, 45056
    s_nop 0
    buffer_load_dwordx4 v23, s[16:19], s100 offen lds
    s_add_u32 m0, s63, 61440
    s_nop 0
    buffer_load_dwordx4 v19, s[16:19], s101 offen offset:0 lds
    buffer_load_dwordx4 v20, s[16:19], s101 offen offset:1024 lds
    buffer_load_dwordx4 v21, s[16:19], s101 offen offset:2048 lds
    buffer_load_dwordx4 v22, s[16:19], s101 offen offset:3072 lds
    s_add_u32 m0, s63, 65536
    s_nop 0
    buffer_load_dwordx4 v23, s[16:19], s101 offen lds
    s_add_u32 m0, s63, 81920
    s_nop 0
    buffer_load_dwordx4 v19, s[16:19], s67 offen offset:0 lds
    buffer_load_dwordx4 v20, s[16:19], s67 offen offset:1024 lds
    buffer_load_dwordx4 v21, s[16:19], s67 offen offset:2048 lds
    buffer_load_dwordx4 v22, s[16:19], s67 offen offset:3072 lds
    s_add_u32 m0, s63, 86016
    s_nop 0
    buffer_load_dwordx4 v23, s[16:19], s67 offen lds
    s_waitcnt vmcnt(0)
    s_barrier
L_slow_wo:
    buffer_load_dword v11, v61, s[24:27], 0 offen offset:384 sc1
    s_waitcnt vmcnt(0)
    v_cmp_ne_u32 vcc, s66, v11
    s_cbranch_vccnz L_spin_13
L_ok_14:
    buffer_load_dwordx4 v[128:131], v54, s[24:27], s53 offen offset:0 sc1
    buffer_load_dwordx4 v[132:135], v54, s[24:27], s53 offen offset:1024 sc1
    buffer_load_dwordx4 v[136:139], v54, s[24:27], s53 offen offset:2048 sc1
    buffer_load_dwordx4 v[140:143], v54, s[24:27], s53 offen offset:3072 sc1
    buffer_load_dwordx2 v[144:145], v0, s[24:27], s53 offen offset:0 sc1
    buffer_load_dwordx2 v[146:147], v0, s[24:27], s53 offen offset:256 sc1
    buffer_load_dwordx4 v[148:151], v55, s[24:27], s53 offen offset:0 sc1
    buffer_load_dwordx4 v[152:155], v55, s[24:27], s53 offen offset:1024 sc1
    buffer_load_dwordx4 v[156:159], v55, s[24:27], s53 offen offset:2048 sc1
    buffer_load_dwordx4 v[160:163], v55, s[24:27], s53 offen offset:3072 sc1
    buffer_load_dwordx2 v[164:165], v59, s[24:27], s53 offen offset:0 sc1
    buffer_load_dwordx2 v[166:167], v59, s[24:27], s53 offen offset:256 sc1
    buffer_load_dword v10, v61, s[24:27], 0 offen offset:384 sc1
    s_waitcnt vmcnt(0)
    v_cmp_ne_u32 vcc, s66, v10
    s_cbranch_vccnz L_spin_15
L_ok_16:
    buffer_load_dwordx4 a[72:75], v54, s[24:27], s1 offen offset:0 sc1
    buffer_load_dwordx4 a[76:79], v54, s[24:27], s1 offen offset:1024 sc1
    buffer_load_dwordx4 a[80:83], v54, s[24:27], s1 offen offset:2048 sc1
    buffer_load_dwordx4 a[84:87], v54, s[24:27], s1 offen offset:3072 sc1
    buffer_load_dwordx2 a[88:89], v0, s[24:27], s1 offen offset:0 sc1
    buffer_load_dwordx2 a[90:91], v0, s[24:27], s1 offen offset:256 sc1
    buffer_load_dwordx4 a[92:95], v55, s[24:27], s1 offen offset:0 sc1
    buffer_load_dwordx4 a[96:99], v55, s[24:27], s1 offen offset:1024 sc1
    buffer_load_dwordx4 a[100:103], v55, s[24:27], s1 offen offset:2048 sc1
    buffer_load_dwordx4 a[104:107], v55, s[24:27], s1 offen offset:3072 sc1
    buffer_load_dwordx2 a[108:109], v59, s[24:27], s1 offen offset:0 sc1
    buffer_load_dwordx2 a[110:111], v59, s[24:27], s1 offen offset:256 sc1
    ds_read_b64_tr_b16 v[216:217], v48 offset:0
    ds_read_b64_tr_b16 v[218:219], v48 offset:1280
    ds_read_b64_tr_b16 v[220:221], v48 offset:8
    ds_read_b64_tr_b16 v[222:223], v48 offset:1288
    ds_read_b64_tr_b16 v[224:225], v48 offset:16
    ds_read_b64_tr_b16 v[226:227], v48 offset:1296
    ds_read_b64_tr_b16 v[228:229], v48 offset:24
    ds_read_b64_tr_b16 v[230:231], v48 offset:1304
    ds_read_b64_tr_b16 v[232:233], v48 offset:32
    ds_read_b64_tr_b16 v[234:235], v48 offset:1312
    ds_read_b64_tr_b16 v[236:237], v48 offset:6400
    ds_read_b64_tr_b16 v[238:239], v48 offset:7680
    ds_read_b64_tr_b16 a[152:153], v48 offset:6408
    ds_read_b64_tr_b16 a[154:155], v48 offset:7688
    s_waitcnt vmcnt(0) lgkmcnt(0)
    s_branch L_join
L_mknonce:
    s_add_u32 s4, s24, 16777216
    s_addc_u32 s5, s25, 0
    s_load_dword s56, s[4:5], 0 glc
    s_waitcnt lgkmcnt(0)
    s_mul_i32 s56, s56, 0x9E3779B5
    s_add_u32 s56, s56, 0x7F4A7C15
    s_cmp_eq_u32 s56, 0
    s_cselect_b32 s56, 0x2545F491, s56
    v_mov_b32 v216, s56
    v_mov_b32 v217, 16777216
    v_mov_b32 v218, 0
    s_mov_b64 exec, 1
    buffer_store_dword v216, v218, s[28:31], 0 offen sc1
    buffer_store_dword v216, v217, s[24:27], 0 offen sc1
    s_mov_b64 exec, -1
    s_branch L_nononce
L_nonce_spin:
    s_mov_b32 s39, 0
L_nonce_top:
    v_mov_b32 v58, 0
    buffer_load_dword v58, v58, s[28:31], 0 offen sc1
    s_add_u32 s39, s39, 1
    s_waitcnt vmcnt(0)
    v_readfirstlane_b32 s66, v58
    s_cmp_ge_u32 s39, 2097152
    s_cbranch_scc1 L_nonce_ok
    s_cmp_eq_u32 s66, 0
    s_cbranch_scc1 L_nonce_top
    s_branch L_nonce_ok
L_spin_1:
    s_mov_b32 s39, 0
L_top_17:
    s_add_u32 s39, s39, 1
    buffer_load_dword v10, v45, s[24:27], 0 offen offset:1280 sc1
    s_waitcnt vmcnt(0)
    v_cmp_ne_u32 vcc, s66, v10
    s_cmp_ge_u32 s39, 2097152
    s_cbranch_scc1 L_ok_2
    s_cbranch_vccnz L_top_17
    s_branch L_ok_2
L_spin_3:
    s_mov_b32 s39, 0
L_top_18:
    s_add_u32 s39, s39, 1
    buffer_load_dword v11, v45, s[24:27], 0 offen offset:0 sc1
    s_waitcnt vmcnt(0)
    v_cmp_ne_u32 vcc, s66, v11
    s_cmp_ge_u32 s39, 2097152
    s_cbranch_scc1 L_ok_4
    s_cbranch_vccnz L_top_18
    s_branch L_ok_4
L_spin_5:
    s_mov_b32 s39, 0
L_top_19:
    s_add_u32 s39, s39, 1
    buffer_load_dword v11, v61, s[24:27], 0 offen offset:384 sc1
    s_waitcnt vmcnt(0)
    v_cmp_ne_u32 vcc, s66, v11
    s_cmp_ge_u32 s39, 2097152
    s_cbranch_scc1 L_ok_6
    s_cbranch_vccnz L_top_19
    s_branch L_ok_6
L_spin_7:
    s_mov_b32 s39, 0
L_top_20:
    s_add_u32 s39, s39, 1
    buffer_load_dword v12, v61, s[24:27], 0 offen offset:256 sc1
    s_waitcnt vmcnt(0)
    v_cmp_ne_u32 vcc, s66, v12
    s_cmp_ge_u32 s39, 2097152
    s_cbranch_scc1 L_ok_8
    s_cbranch_vccnz L_top_20
    s_branch L_ok_8
L_spin_9:
    s_mov_b32 s39, 0
L_top_21:
    s_add_u32 s39, s39, 1
    buffer_load_dword v13, v61, s[24:27], 0 offen offset:128 sc1
    s_waitcnt vmcnt(0)
    v_cmp_ne_u32 vcc, s66, v13
    s_cmp_ge_u32 s39, 2097152
    s_cbranch_scc1 L_ok_10
    s_cbranch_vccnz L_top_21
    s_branch L_ok_10
L_spin_11:
    s_mov_b32 s39, 0
L_top_22:
    s_add_u32 s39, s39, 1
    buffer_load_dword v10, v2, s[24:27], 0 offen offset:0 sc1
    s_waitcnt vmcnt(0)
    v_cmp_ne_u32 vcc, s66, v10
    s_cmp_ge_u32 s39, 2097152
    s_cbranch_scc1 L_ok_12
    s_cbranch_vccnz L_top_22
    s_branch L_ok_12
L_spin_13:
    s_mov_b32 s39, 0
L_top_23:
    s_add_u32 s39, s39, 1
    buffer_load_dword v11, v61, s[24:27], 0 offen offset:384 sc1
    s_waitcnt vmcnt(0)
    v_cmp_ne_u32 vcc, s66, v11
    s_cmp_ge_u32 s39, 2097152
    s_cbranch_scc1 L_ok_14
    s_cbranch_vccnz L_top_23
    s_branch L_ok_14
L_spin_15:
    s_mov_b32 s39, 0
L_top_24:
    s_add_u32 s39, s39, 1
    buffer_load_dword v10, v61, s[24:27], 0 offen offset:384 sc1
    s_waitcnt vmcnt(0)
    v_cmp_ne_u32 vcc, s66, v10
    s_cmp_ge_u32 s39, 2097152
    s_cbranch_scc1 L_ok_16
    s_cbranch_vccnz L_top_24
    s_branch L_ok_16
L_exit:
    s_endpgm
.section .rodata,"a"
.p2align 6
.amdhsa_kernel concat_heads__sliding_block__sliding_block__prompt_kernel
  .amdhsa_next_free_vgpr 512
  .amdhsa_next_free_sgpr 102
  .amdhsa_accum_offset 256
  .amdhsa_group_segment_fixed_size 0
  .amdhsa_kernarg_size 72
  .amdhsa_user_sgpr_count 2
  .amdhsa_user_sgpr_kernarg_segment_ptr 1
  .amdhsa_system_sgpr_workgroup_id_x 1
.end_amdhsa_kernel
```
